```python
import torch

def _softmax(x, axis=-1):
    return torch.softmax(x, dim=axis)
def _gelu(x):
    return torch.nn.functional.gelu(x, approximate="tanh")
def _silu(x):
    return torch.nn.functional.silu(x)
def _sigmoid(x):
    return torch.sigmoid(x)
def _layernorm(x, axis=-1, eps=1e-5):
    m = x.mean(dim=axis, keepdim=True)
    v = x.var(dim=axis, keepdim=True, unbiased=False)
    return (x - m) / torch.sqrt(v + eps)
def _scatter_add(tgt, idx, src, axis=0):
    return tgt.clone().index_add_(axis, idx, src)
def _segment_sum(src, seg, n):
    out = torch.zeros((n,) + src.shape[1:], dtype=src.dtype)
    return out.index_add_(0, seg, src)
def _pad(x, pw):
    flat = tuple(v for pair in reversed(pw) for v in pair)
    return torch.nn.functional.pad(x, flat)

kernel_name = 'parallel_sum__spectral_gfnet__glu_gated_geglu__prompt'

def setup_inputs():

    _w = (lambda a: (lambda t: t.to(torch.bfloat16) if t.is_floating_point() else t)(torch.as_tensor(a)))
    def _A_setup():
        B, S, D = 1, 2048, 448
        Df = D // 2 + 1
        return {
            "x": _w((lambda *s: torch.randn(*s, dtype=torch.bfloat16) * 0.05)(B, S, D)),
            "w_r": _w((lambda *s: torch.randn(*s, dtype=torch.bfloat16) * 0.8)(S, Df) * 0.02),
            "w_i": _w((lambda *s: torch.randn(*s, dtype=torch.bfloat16) * 0.8)(S, Df) * 0.02),
        }
    _A_in = _A_setup()

    def _B_setup():
        B, S, Dm, Df = 1, 2048, 448, 1792
        return {
            "x": _w((lambda *s: torch.randn(*s, dtype=torch.bfloat16) * 0.05)(B, S, Dm)),
            "w_gate": _w((lambda *s: torch.randn(*s, dtype=torch.bfloat16) * 0.4)(Dm, Df) * (Dm ** -0.5)),
            "w_up": _w((lambda *s: torch.randn(*s, dtype=torch.bfloat16) * 0.4)(Dm, Df) * (Dm ** -0.5)),
            "w_down": _w((lambda *s: torch.randn(*s, dtype=torch.bfloat16) * 0.4)(Df, Dm) * (Df ** -0.5)),
        }
    _B_in = _B_setup()

    return {
        "A_x": _A_in["x"],
        "A_w_r": _A_in["w_r"],
        "A_w_i": _A_in["w_i"],
        "B_x": _B_in["x"],
        "B_w_gate": _B_in["w_gate"],
        "B_w_up": _B_in["w_up"],
        "B_w_down": _B_in["w_down"],
    }

def reference(A_x, A_w_r, A_w_i, B_x, B_w_gate, B_w_up, B_w_down):
    def _A_ref(x, w_r, w_i):
        B, S, D = x.shape
        X = (lambda x, axes=(-2,-1): torch.fft.rfft2(x.float(), dim=axes))(x, axes=(-2, -1))
        W = w_r + 1j * w_i
        X = X * W
        y = (lambda x, s, axes=(-2,-1): torch.fft.irfft2(x, s=s, dim=axes).to(torch.bfloat16))(X, (S, D), axes=(-2, -1))
        return y

    def _B_ref(x, w_gate, w_up, w_down):
        g = torch.einsum("bsd,df->bsf", x, w_gate)
        u = torch.einsum("bsd,df->bsf", x, w_up)
        h = _gelu(g) * u
        return torch.einsum("bsf,fd->bsd", h, w_down)

    x = A_x
    xn = _layernorm(x, axis=-1)
    return x + _A_ref(xn, A_w_r, A_w_i) + _B_ref(xn, B_w_gate, B_w_up, B_w_down)
```

```asm
; @launch kernel=k0_kernel grid=(256,1,1) block=(512,1,1) lds=29696
; @launch kernel=k1_kernel grid=(256,1,1) block=(512,1,1) lds=147456
; @launch kernel=k3_kernel grid=(224,1,1) block=(512,1,1) lds=114688
.amdgcn_target "amdgcn-amd-amdhsa--gfx950"
.text
.globl k0_kernel
.p2align 8
.type k0_kernel,@function
k0_kernel:
    s_cmp_ge_u32 s2, 256
    s_cbranch_scc1 L_k0_end
    s_load_dwordx16 s[16:31], s[0:1], 0
    s_load_dwordx4 s[32:35], s[0:1], 64
    v_lshrrev_b32 v1, 6, v0
    s_and_b32 s3, s2, 7
    s_lshl_b32 s3, s3, 3
    s_lshr_b32 s4, s2, 5
    s_add_u32 s3, s3, s4
    s_bfe_u32 s4, s2, 0x20003
    v_readfirstlane_b32 s6, v1
    s_mov_b32 s7, 0x3b124925
    v_lshrrev_b32 v1, 4, v0
    s_and_b32 s8, s4, 1
    s_lshl_b32 s8, s8, 4
    v_xor_b32 v1, s8, v1
    v_and_b32 v2, 15, v0
    v_mul_u32_u24 v3, 896, v1
    v_lshl_add_u32 v3, v2, 3, v3
    s_mul_i32 s5, s3, 28672
    s_waitcnt lgkmcnt(0)
    s_mov_b32 s36, s16
    s_mov_b32 s37, s17
    s_mov_b32 s38, 0x1c0000
    s_mov_b32 s39, 0x00020000
    s_mov_b32 s40, s34
    s_mov_b32 s41, s35
    s_mov_b32 s42, 0x1c0000
    s_mov_b32 s43, 0x00020000
    buffer_load_dwordx2 v[8:9], v3, s[36:39], s5 offen offset:0
    buffer_load_dwordx2 v[10:11], v3, s[36:39], s5 offen offset:128
    buffer_load_dwordx2 v[12:13], v3, s[36:39], s5 offen offset:256
    buffer_load_dwordx2 v[14:15], v3, s[36:39], s5 offen offset:384
    buffer_load_dwordx2 v[16:17], v3, s[36:39], s5 offen offset:512
    buffer_load_dwordx2 v[18:19], v3, s[36:39], s5 offen offset:640
    buffer_load_dwordx2 v[20:21], v3, s[36:39], s5 offen offset:768
    s_cmp_ge_u32 s6, 4
    s_cbranch_scc1 L_k0_bgen
    s_waitcnt vmcnt(0)
    s_mov_b32 s52, s18
    s_mov_b32 s53, s19
    s_mov_b32 s54, 0xe1000
    s_mov_b32 s55, 0x00020000
    s_mov_b32 s56, s20
    s_mov_b32 s57, s21
    s_mov_b32 s58, 0xe1000
    s_mov_b32 s59, 0x00020000
    s_add_u32 s60, s34, 0x1000000
    s_addc_u32 s61, s35, 0
    s_mov_b32 s62, 0x1d0100
    s_mov_b32 s63, 0x00020000
    s_lshl_b32 s8, s4, 3
    s_lshl_b32 s8, s8, 6
    s_add_u32 s8, s8, s3
    s_mul_i32 s8, s8, 450
    v_lshlrev_b32 v36, 1, v0
    s_add_u32 s9, s8, 0
    buffer_load_ushort v112, v36, s[52:55], s9 offen
    s_add_u32 s9, s8, 0
    buffer_load_ushort v120, v36, s[56:59], s9 offen
    s_add_u32 s9, s8, 28800
    buffer_load_ushort v113, v36, s[52:55], s9 offen
    s_add_u32 s9, s8, 28800
    buffer_load_ushort v121, v36, s[56:59], s9 offen
    s_add_u32 s9, s8, 57600
    buffer_load_ushort v114, v36, s[52:55], s9 offen
    s_add_u32 s9, s8, 57600
    buffer_load_ushort v122, v36, s[56:59], s9 offen
    s_add_u32 s9, s8, 86400
    buffer_load_ushort v115, v36, s[52:55], s9 offen
    s_add_u32 s9, s8, 86400
    buffer_load_ushort v123, v36, s[56:59], s9 offen
    s_add_u32 s9, s8, 115200
    buffer_load_ushort v116, v36, s[52:55], s9 offen
    s_add_u32 s9, s8, 115200
    buffer_load_ushort v124, v36, s[56:59], s9 offen
    s_add_u32 s9, s8, 144000
    buffer_load_ushort v117, v36, s[52:55], s9 offen
    s_add_u32 s9, s8, 144000
    buffer_load_ushort v125, v36, s[56:59], s9 offen
    s_add_u32 s9, s8, 172800
    buffer_load_ushort v118, v36, s[52:55], s9 offen
    s_add_u32 s9, s8, 172800
    buffer_load_ushort v126, v36, s[56:59], s9 offen
    s_add_u32 s9, s8, 201600
    buffer_load_ushort v119, v36, s[52:55], s9 offen
    s_add_u32 s9, s8, 201600
    buffer_load_ushort v127, v36, s[56:59], s9 offen
    s_lshl_b32 s9, s2, 12
    v_lshl_add_u32 v37, v0, 4, s9
    s_mov_b32 s9, 0x100000
    s_mov_b32 s64, s24
    s_mov_b32 s65, s25
    s_mov_b32 s66, 0x188000
    s_mov_b32 s67, 0x00020000
    s_mov_b32 s68, s26
    s_mov_b32 s69, s27
    s_mov_b32 s70, 0x188000
    s_mov_b32 s71, 0x00020000
    s_mov_b32 s12, s28
    s_mov_b32 s13, s29
    s_mov_b32 s14, 0x188000
    s_mov_b32 s15, 0x00020000
    buffer_load_dwordx4 v[144:147], v37, s[12:15], 0 offen
    buffer_load_dwordx4 v[148:151], v37, s[12:15], s9 offen
    buffer_load_dwordx4 v[136:139], v37, s[64:67], 0 offen
    buffer_load_dwordx4 v[148:151], v37, s[64:67], s9 offen
    buffer_load_dwordx4 v[140:143], v37, s[68:71], 0 offen
    buffer_load_dwordx4 v[152:155], v37, s[68:71], s9 offen
    s_branch L_k0_ln
L_k0_bgen:
    s_cmp_ge_u32 s2, 72
    s_cbranch_scc1 L_k0_nopf
    s_getpc_b64 s[96:97]
L_k0_pc:
    s_mov_b32 s98, k1_kernel-L_k0_pc
    s_mov_b32 s99, L_k3_end-k1_kernel-4
    s_cmp_lt_u32 s2, 8
    s_cselect_b32 s98, k0_kernel-L_k0_pc, s98
    s_cselect_b32 s99, L_k0_end-k0_kernel-4, s99
    s_ashr_i32 s100, s98, 31
    s_add_u32 s96, s96, s98
    s_addc_u32 s97, s97, s100
    s_cmp_lt_u32 s2, 8
    s_cselect_b32 s100, 2, 3
    s_lshr_b32 s101, s2, 3
    s_max_u32 s101, s101, 1
    s_sub_u32 s101, s101, 1
    s_lshl_b32 s101, s101, 5
    v_and_b32 v98, 255, v0
    v_lshrrev_b32 v98, s100, v98
    v_add_lshl_u32 v98, v98, s101, 7
    v_min_u32 v98, s99, v98
    global_load_dword v99, v98, s[96:97]
L_k0_nopf:
    v_and_b32 v4, 15, v0
    v_bfe_u32 v5, v0, 6, 2
    v_lshl_add_u32 v4, v5, 4, v4
    s_lshl_b32 s8, s4, 6
    v_add_u32 v4, s8, v4
    v_bfe_u32 v5, v0, 4, 2
    v_lshlrev_b32 v5, 3, v5
    v_mul_u32_u24 v80, v5, v4
    v_add_u32 v83, v80, v4
    v_lshlrev_b32 v86, 1, v4
    v_lshlrev_b32 v89, 2, v4
    v_lshlrev_b32 v92, 5, v4
    v_lshrrev_b32 v81, 6, v80
    v_mul_u32_u24 v81, 9363, v81
    v_lshrrev_b32 v81, 16, v81
    v_mul_u32_u24 v81, 448, v81
    v_sub_u32 v82, v80, v81
    v_cvt_f32_u32 v82, v82
    v_mul_f32 v82, s7, v82
    v_cos_f32 v40, v82
    v_sin_f32 v48, v82
    v_lshrrev_b32 v84, 6, v83
    v_mul_u32_u24 v84, 9363, v84
    v_lshrrev_b32 v84, 16, v84
    v_mul_u32_u24 v84, 448, v84
    v_sub_u32 v85, v83, v84
    v_cvt_f32_u32 v85, v85
    v_mul_f32 v85, s7, v85
    v_cos_f32 v41, v85
    v_sin_f32 v49, v85
    v_lshrrev_b32 v87, 6, v86
    v_mul_u32_u24 v87, 9363, v87
    v_lshrrev_b32 v87, 16, v87
    v_mul_u32_u24 v87, 448, v87
    v_sub_u32 v88, v86, v87
    v_cvt_f32_u32 v88, v88
    v_mul_f32 v88, s7, v88
    v_cos_f32 v72, v88
    v_sin_f32 v73, v88
    v_lshrrev_b32 v90, 6, v89
    v_mul_u32_u24 v90, 9363, v90
    v_lshrrev_b32 v90, 16, v90
    v_mul_u32_u24 v90, 448, v90
    v_sub_u32 v91, v89, v90
    v_cvt_f32_u32 v91, v91
    v_mul_f32 v91, s7, v91
    v_cos_f32 v74, v91
    v_sin_f32 v75, v91
    v_lshrrev_b32 v93, 6, v92
    v_mul_u32_u24 v93, 9363, v93
    v_lshrrev_b32 v93, 16, v93
    v_mul_u32_u24 v93, 448, v93
    v_sub_u32 v94, v92, v93
    v_cvt_f32_u32 v94, v94
    v_mul_f32 v94, s7, v94
    v_cos_f32 v76, v94
    v_sin_f32 v77, v94
    s_nop 0
    v_pk_mul_f32 v[42:43], v[40:41], v[72:73] op_sel:[0,0] op_sel_hi:[1,0]
    v_pk_mul_f32 v[50:51], v[48:49], v[72:73] op_sel:[0,0] op_sel_hi:[1,0]
    v_pk_fma_f32 v[42:43], v[48:49], v[72:73], v[42:43] op_sel:[0,1,0] op_sel_hi:[1,1,1] neg_lo:[1,0,0] neg_hi:[1,0,0]
    v_pk_fma_f32 v[50:51], v[40:41], v[72:73], v[50:51] op_sel:[0,1,0] op_sel_hi:[1,1,1]
    v_pk_mul_f32 v[44:45], v[40:41], v[74:75] op_sel:[0,0] op_sel_hi:[1,0]
    v_pk_mul_f32 v[52:53], v[48:49], v[74:75] op_sel:[0,0] op_sel_hi:[1,0]
    v_pk_fma_f32 v[44:45], v[48:49], v[74:75], v[44:45] op_sel:[0,1,0] op_sel_hi:[1,1,1] neg_lo:[1,0,0] neg_hi:[1,0,0]
    v_pk_fma_f32 v[52:53], v[40:41], v[74:75], v[52:53] op_sel:[0,1,0] op_sel_hi:[1,1,1]
    v_pk_mul_f32 v[46:47], v[42:43], v[74:75] op_sel:[0,0] op_sel_hi:[1,0]
    v_pk_mul_f32 v[54:55], v[50:51], v[74:75] op_sel:[0,0] op_sel_hi:[1,0]
    v_pk_fma_f32 v[46:47], v[50:51], v[74:75], v[46:47] op_sel:[0,1,0] op_sel_hi:[1,1,1] neg_lo:[1,0,0] neg_hi:[1,0,0]
    v_pk_fma_f32 v[54:55], v[42:43], v[74:75], v[54:55] op_sel:[0,1,0] op_sel_hi:[1,1,1]
    v_pk_mul_f32 v[56:57], v[40:41], v[76:77] op_sel:[0,0] op_sel_hi:[1,0]
    v_pk_mul_f32 v[64:65], v[48:49], v[76:77] op_sel:[0,0] op_sel_hi:[1,0]
    v_pk_fma_f32 v[56:57], v[48:49], v[76:77], v[56:57] op_sel:[0,1,0] op_sel_hi:[1,1,1] neg_lo:[1,0,0] neg_hi:[1,0,0]
    v_pk_fma_f32 v[64:65], v[40:41], v[76:77], v[64:65] op_sel:[0,1,0] op_sel_hi:[1,1,1]
    v_pk_mul_f32 v[58:59], v[42:43], v[76:77] op_sel:[0,0] op_sel_hi:[1,0]
    v_pk_mul_f32 v[66:67], v[50:51], v[76:77] op_sel:[0,0] op_sel_hi:[1,0]
    v_pk_fma_f32 v[58:59], v[50:51], v[76:77], v[58:59] op_sel:[0,1,0] op_sel_hi:[1,1,1] neg_lo:[1,0,0] neg_hi:[1,0,0]
    v_pk_fma_f32 v[66:67], v[42:43], v[76:77], v[66:67] op_sel:[0,1,0] op_sel_hi:[1,1,1]
    v_pk_mul_f32 v[60:61], v[44:45], v[76:77] op_sel:[0,0] op_sel_hi:[1,0]
    v_pk_mul_f32 v[68:69], v[52:53], v[76:77] op_sel:[0,0] op_sel_hi:[1,0]
    v_pk_fma_f32 v[60:61], v[52:53], v[76:77], v[60:61] op_sel:[0,1,0] op_sel_hi:[1,1,1] neg_lo:[1,0,0] neg_hi:[1,0,0]
    v_pk_fma_f32 v[68:69], v[44:45], v[76:77], v[68:69] op_sel:[0,1,0] op_sel_hi:[1,1,1]
    v_pk_mul_f32 v[62:63], v[46:47], v[76:77] op_sel:[0,0] op_sel_hi:[1,0]
    v_pk_mul_f32 v[70:71], v[54:55], v[76:77] op_sel:[0,0] op_sel_hi:[1,0]
    v_pk_fma_f32 v[62:63], v[54:55], v[76:77], v[62:63] op_sel:[0,1,0] op_sel_hi:[1,1,1] neg_lo:[1,0,0] neg_hi:[1,0,0]
    v_pk_fma_f32 v[70:71], v[46:47], v[76:77], v[70:71] op_sel:[0,1,0] op_sel_hi:[1,1,1]
    v_add_f32 v72, v76, v76
    v_cvt_pk_bf16_f32 v100, v40, v41
    v_cvt_pk_bf16_f32 v104, -v48, -v49
    v_cvt_pk_bf16_f32 v101, v42, v43
    v_cvt_pk_bf16_f32 v105, -v50, -v51
    v_cvt_pk_bf16_f32 v102, v44, v45
    v_cvt_pk_bf16_f32 v106, -v52, -v53
    v_cvt_pk_bf16_f32 v103, v46, v47
    v_cvt_pk_bf16_f32 v107, -v54, -v55
    v_pk_fma_f32 v[40:41], v[56:57], v[72:73], v[40:41] op_sel:[0,0,0] op_sel_hi:[1,0,1] neg_lo:[0,0,1] neg_hi:[0,0,1]
    v_pk_fma_f32 v[48:49], v[64:65], v[72:73], v[48:49] op_sel:[0,0,0] op_sel_hi:[1,0,1] neg_lo:[0,0,1] neg_hi:[0,0,1]
    v_pk_fma_f32 v[42:43], v[58:59], v[72:73], v[42:43] op_sel:[0,0,0] op_sel_hi:[1,0,1] neg_lo:[0,0,1] neg_hi:[0,0,1]
    v_pk_fma_f32 v[50:51], v[66:67], v[72:73], v[50:51] op_sel:[0,0,0] op_sel_hi:[1,0,1] neg_lo:[0,0,1] neg_hi:[0,0,1]
    v_pk_fma_f32 v[44:45], v[60:61], v[72:73], v[44:45] op_sel:[0,0,0] op_sel_hi:[1,0,1] neg_lo:[0,0,1] neg_hi:[0,0,1]
    v_pk_fma_f32 v[52:53], v[68:69], v[72:73], v[52:53] op_sel:[0,0,0] op_sel_hi:[1,0,1] neg_lo:[0,0,1] neg_hi:[0,0,1]
    v_pk_fma_f32 v[46:47], v[62:63], v[72:73], v[46:47] op_sel:[0,0,0] op_sel_hi:[1,0,1] neg_lo:[0,0,1] neg_hi:[0,0,1]
    v_pk_fma_f32 v[54:55], v[70:71], v[72:73], v[54:55] op_sel:[0,0,0] op_sel_hi:[1,0,1] neg_lo:[0,0,1] neg_hi:[0,0,1]
    v_cvt_pk_bf16_f32 v108, v56, v57
    v_cvt_pk_bf16_f32 v112, -v64, -v65
    v_cvt_pk_bf16_f32 v109, v58, v59
    v_cvt_pk_bf16_f32 v113, -v66, -v67
    v_cvt_pk_bf16_f32 v110, v60, v61
    v_cvt_pk_bf16_f32 v114, -v68, -v69
    v_cvt_pk_bf16_f32 v111, v62, v63
    v_cvt_pk_bf16_f32 v115, -v70, -v71
    v_pk_fma_f32 v[56:57], v[40:41], v[72:73], v[56:57] op_sel:[0,0,0] op_sel_hi:[1,0,1] neg_lo:[0,0,1] neg_hi:[0,0,1]
    v_pk_fma_f32 v[64:65], v[48:49], v[72:73], v[64:65] op_sel:[0,0,0] op_sel_hi:[1,0,1] neg_lo:[0,0,1] neg_hi:[0,0,1]
    v_pk_fma_f32 v[58:59], v[42:43], v[72:73], v[58:59] op_sel:[0,0,0] op_sel_hi:[1,0,1] neg_lo:[0,0,1] neg_hi:[0,0,1]
    v_pk_fma_f32 v[66:67], v[50:51], v[72:73], v[66:67] op_sel:[0,0,0] op_sel_hi:[1,0,1] neg_lo:[0,0,1] neg_hi:[0,0,1]
    v_pk_fma_f32 v[60:61], v[44:45], v[72:73], v[60:61] op_sel:[0,0,0] op_sel_hi:[1,0,1] neg_lo:[0,0,1] neg_hi:[0,0,1]
    v_pk_fma_f32 v[68:69], v[52:53], v[72:73], v[68:69] op_sel:[0,0,0] op_sel_hi:[1,0,1] neg_lo:[0,0,1] neg_hi:[0,0,1]
    v_pk_fma_f32 v[62:63], v[46:47], v[72:73], v[62:63] op_sel:[0,0,0] op_sel_hi:[1,0,1] neg_lo:[0,0,1] neg_hi:[0,0,1]
    v_pk_fma_f32 v[70:71], v[54:55], v[72:73], v[70:71] op_sel:[0,0,0] op_sel_hi:[1,0,1] neg_lo:[0,0,1] neg_hi:[0,0,1]
    v_cvt_pk_bf16_f32 v116, v40, v41
    v_cvt_pk_bf16_f32 v120, -v48, -v49
    v_cvt_pk_bf16_f32 v117, v42, v43
    v_cvt_pk_bf16_f32 v121, -v50, -v51
    v_cvt_pk_bf16_f32 v118, v44, v45
    v_cvt_pk_bf16_f32 v122, -v52, -v53
    v_cvt_pk_bf16_f32 v119, v46, v47
    v_cvt_pk_bf16_f32 v123, -v54, -v55
    v_pk_fma_f32 v[40:41], v[56:57], v[72:73], v[40:41] op_sel:[0,0,0] op_sel_hi:[1,0,1] neg_lo:[0,0,1] neg_hi:[0,0,1]
    v_pk_fma_f32 v[48:49], v[64:65], v[72:73], v[48:49] op_sel:[0,0,0] op_sel_hi:[1,0,1] neg_lo:[0,0,1] neg_hi:[0,0,1]
    v_pk_fma_f32 v[42:43], v[58:59], v[72:73], v[42:43] op_sel:[0,0,0] op_sel_hi:[1,0,1] neg_lo:[0,0,1] neg_hi:[0,0,1]
    v_pk_fma_f32 v[50:51], v[66:67], v[72:73], v[50:51] op_sel:[0,0,0] op_sel_hi:[1,0,1] neg_lo:[0,0,1] neg_hi:[0,0,1]
    v_pk_fma_f32 v[44:45], v[60:61], v[72:73], v[44:45] op_sel:[0,0,0] op_sel_hi:[1,0,1] neg_lo:[0,0,1] neg_hi:[0,0,1]
    v_pk_fma_f32 v[52:53], v[68:69], v[72:73], v[52:53] op_sel:[0,0,0] op_sel_hi:[1,0,1] neg_lo:[0,0,1] neg_hi:[0,0,1]
    v_pk_fma_f32 v[46:47], v[62:63], v[72:73], v[46:47] op_sel:[0,0,0] op_sel_hi:[1,0,1] neg_lo:[0,0,1] neg_hi:[0,0,1]
    v_pk_fma_f32 v[54:55], v[70:71], v[72:73], v[54:55] op_sel:[0,0,0] op_sel_hi:[1,0,1] neg_lo:[0,0,1] neg_hi:[0,0,1]
    v_cvt_pk_bf16_f32 v124, v56, v57
    v_cvt_pk_bf16_f32 v128, -v64, -v65
    v_cvt_pk_bf16_f32 v125, v58, v59
    v_cvt_pk_bf16_f32 v129, -v66, -v67
    v_cvt_pk_bf16_f32 v126, v60, v61
    v_cvt_pk_bf16_f32 v130, -v68, -v69
    v_cvt_pk_bf16_f32 v127, v62, v63
    v_cvt_pk_bf16_f32 v131, -v70, -v71
    v_pk_fma_f32 v[56:57], v[40:41], v[72:73], v[56:57] op_sel:[0,0,0] op_sel_hi:[1,0,1] neg_lo:[0,0,1] neg_hi:[0,0,1]
    v_pk_fma_f32 v[64:65], v[48:49], v[72:73], v[64:65] op_sel:[0,0,0] op_sel_hi:[1,0,1] neg_lo:[0,0,1] neg_hi:[0,0,1]
    v_pk_fma_f32 v[58:59], v[42:43], v[72:73], v[58:59] op_sel:[0,0,0] op_sel_hi:[1,0,1] neg_lo:[0,0,1] neg_hi:[0,0,1]
    v_pk_fma_f32 v[66:67], v[50:51], v[72:73], v[66:67] op_sel:[0,0,0] op_sel_hi:[1,0,1] neg_lo:[0,0,1] neg_hi:[0,0,1]
    v_pk_fma_f32 v[60:61], v[44:45], v[72:73], v[60:61] op_sel:[0,0,0] op_sel_hi:[1,0,1] neg_lo:[0,0,1] neg_hi:[0,0,1]
    v_pk_fma_f32 v[68:69], v[52:53], v[72:73], v[68:69] op_sel:[0,0,0] op_sel_hi:[1,0,1] neg_lo:[0,0,1] neg_hi:[0,0,1]
    v_pk_fma_f32 v[62:63], v[46:47], v[72:73], v[62:63] op_sel:[0,0,0] op_sel_hi:[1,0,1] neg_lo:[0,0,1] neg_hi:[0,0,1]
    v_pk_fma_f32 v[70:71], v[54:55], v[72:73], v[70:71] op_sel:[0,0,0] op_sel_hi:[1,0,1] neg_lo:[0,0,1] neg_hi:[0,0,1]
    v_cvt_pk_bf16_f32 v132, v40, v41
    v_cvt_pk_bf16_f32 v136, -v48, -v49
    v_cvt_pk_bf16_f32 v133, v42, v43
    v_cvt_pk_bf16_f32 v137, -v50, -v51
    v_cvt_pk_bf16_f32 v134, v44, v45
    v_cvt_pk_bf16_f32 v138, -v52, -v53
    v_cvt_pk_bf16_f32 v135, v46, v47
    v_cvt_pk_bf16_f32 v139, -v54, -v55
    v_pk_fma_f32 v[40:41], v[56:57], v[72:73], v[40:41] op_sel:[0,0,0] op_sel_hi:[1,0,1] neg_lo:[0,0,1] neg_hi:[0,0,1]
    v_pk_fma_f32 v[48:49], v[64:65], v[72:73], v[48:49] op_sel:[0,0,0] op_sel_hi:[1,0,1] neg_lo:[0,0,1] neg_hi:[0,0,1]
    v_pk_fma_f32 v[42:43], v[58:59], v[72:73], v[42:43] op_sel:[0,0,0] op_sel_hi:[1,0,1] neg_lo:[0,0,1] neg_hi:[0,0,1]
    v_pk_fma_f32 v[50:51], v[66:67], v[72:73], v[50:51] op_sel:[0,0,0] op_sel_hi:[1,0,1] neg_lo:[0,0,1] neg_hi:[0,0,1]
    v_pk_fma_f32 v[44:45], v[60:61], v[72:73], v[44:45] op_sel:[0,0,0] op_sel_hi:[1,0,1] neg_lo:[0,0,1] neg_hi:[0,0,1]
    v_pk_fma_f32 v[52:53], v[68:69], v[72:73], v[52:53] op_sel:[0,0,0] op_sel_hi:[1,0,1] neg_lo:[0,0,1] neg_hi:[0,0,1]
    v_pk_fma_f32 v[46:47], v[62:63], v[72:73], v[46:47] op_sel:[0,0,0] op_sel_hi:[1,0,1] neg_lo:[0,0,1] neg_hi:[0,0,1]
    v_pk_fma_f32 v[54:55], v[70:71], v[72:73], v[54:55] op_sel:[0,0,0] op_sel_hi:[1,0,1] neg_lo:[0,0,1] neg_hi:[0,0,1]
    v_cvt_pk_bf16_f32 v140, v56, v57
    v_cvt_pk_bf16_f32 v144, -v64, -v65
    v_cvt_pk_bf16_f32 v141, v58, v59
    v_cvt_pk_bf16_f32 v145, -v66, -v67
    v_cvt_pk_bf16_f32 v142, v60, v61
    v_cvt_pk_bf16_f32 v146, -v68, -v69
    v_cvt_pk_bf16_f32 v143, v62, v63
    v_cvt_pk_bf16_f32 v147, -v70, -v71
    v_pk_fma_f32 v[56:57], v[40:41], v[72:73], v[56:57] op_sel:[0,0,0] op_sel_hi:[1,0,1] neg_lo:[0,0,1] neg_hi:[0,0,1]
    v_pk_fma_f32 v[64:65], v[48:49], v[72:73], v[64:65] op_sel:[0,0,0] op_sel_hi:[1,0,1] neg_lo:[0,0,1] neg_hi:[0,0,1]
    v_pk_fma_f32 v[58:59], v[42:43], v[72:73], v[58:59] op_sel:[0,0,0] op_sel_hi:[1,0,1] neg_lo:[0,0,1] neg_hi:[0,0,1]
    v_pk_fma_f32 v[66:67], v[50:51], v[72:73], v[66:67] op_sel:[0,0,0] op_sel_hi:[1,0,1] neg_lo:[0,0,1] neg_hi:[0,0,1]
    v_pk_fma_f32 v[60:61], v[44:45], v[72:73], v[60:61] op_sel:[0,0,0] op_sel_hi:[1,0,1] neg_lo:[0,0,1] neg_hi:[0,0,1]
    v_pk_fma_f32 v[68:69], v[52:53], v[72:73], v[68:69] op_sel:[0,0,0] op_sel_hi:[1,0,1] neg_lo:[0,0,1] neg_hi:[0,0,1]
    v_pk_fma_f32 v[62:63], v[46:47], v[72:73], v[62:63] op_sel:[0,0,0] op_sel_hi:[1,0,1] neg_lo:[0,0,1] neg_hi:[0,0,1]
    v_pk_fma_f32 v[70:71], v[54:55], v[72:73], v[70:71] op_sel:[0,0,0] op_sel_hi:[1,0,1] neg_lo:[0,0,1] neg_hi:[0,0,1]
    v_cvt_pk_bf16_f32 v148, v40, v41
    v_cvt_pk_bf16_f32 v152, -v48, -v49
    v_cvt_pk_bf16_f32 v149, v42, v43
    v_cvt_pk_bf16_f32 v153, -v50, -v51
    v_cvt_pk_bf16_f32 v150, v44, v45
    v_cvt_pk_bf16_f32 v154, -v52, -v53
    v_cvt_pk_bf16_f32 v151, v46, v47
    v_cvt_pk_bf16_f32 v155, -v54, -v55
    v_pk_fma_f32 v[40:41], v[56:57], v[72:73], v[40:41] op_sel:[0,0,0] op_sel_hi:[1,0,1] neg_lo:[0,0,1] neg_hi:[0,0,1]
    v_pk_fma_f32 v[48:49], v[64:65], v[72:73], v[48:49] op_sel:[0,0,0] op_sel_hi:[1,0,1] neg_lo:[0,0,1] neg_hi:[0,0,1]
    v_pk_fma_f32 v[42:43], v[58:59], v[72:73], v[42:43] op_sel:[0,0,0] op_sel_hi:[1,0,1] neg_lo:[0,0,1] neg_hi:[0,0,1]
    v_pk_fma_f32 v[50:51], v[66:67], v[72:73], v[50:51] op_sel:[0,0,0] op_sel_hi:[1,0,1] neg_lo:[0,0,1] neg_hi:[0,0,1]
    v_pk_fma_f32 v[44:45], v[60:61], v[72:73], v[44:45] op_sel:[0,0,0] op_sel_hi:[1,0,1] neg_lo:[0,0,1] neg_hi:[0,0,1]
    v_pk_fma_f32 v[52:53], v[68:69], v[72:73], v[52:53] op_sel:[0,0,0] op_sel_hi:[1,0,1] neg_lo:[0,0,1] neg_hi:[0,0,1]
    v_pk_fma_f32 v[46:47], v[62:63], v[72:73], v[46:47] op_sel:[0,0,0] op_sel_hi:[1,0,1] neg_lo:[0,0,1] neg_hi:[0,0,1]
    v_pk_fma_f32 v[54:55], v[70:71], v[72:73], v[54:55] op_sel:[0,0,0] op_sel_hi:[1,0,1] neg_lo:[0,0,1] neg_hi:[0,0,1]
    v_cvt_pk_bf16_f32 v156, v56, v57
    v_cvt_pk_bf16_f32 v160, -v64, -v65
    v_cvt_pk_bf16_f32 v157, v58, v59
    v_cvt_pk_bf16_f32 v161, -v66, -v67
    v_cvt_pk_bf16_f32 v158, v60, v61
    v_cvt_pk_bf16_f32 v162, -v68, -v69
    v_cvt_pk_bf16_f32 v159, v62, v63
    v_cvt_pk_bf16_f32 v163, -v70, -v71
    v_pk_fma_f32 v[56:57], v[40:41], v[72:73], v[56:57] op_sel:[0,0,0] op_sel_hi:[1,0,1] neg_lo:[0,0,1] neg_hi:[0,0,1]
    v_pk_fma_f32 v[64:65], v[48:49], v[72:73], v[64:65] op_sel:[0,0,0] op_sel_hi:[1,0,1] neg_lo:[0,0,1] neg_hi:[0,0,1]
    v_pk_fma_f32 v[58:59], v[42:43], v[72:73], v[58:59] op_sel:[0,0,0] op_sel_hi:[1,0,1] neg_lo:[0,0,1] neg_hi:[0,0,1]
    v_pk_fma_f32 v[66:67], v[50:51], v[72:73], v[66:67] op_sel:[0,0,0] op_sel_hi:[1,0,1] neg_lo:[0,0,1] neg_hi:[0,0,1]
    v_pk_fma_f32 v[60:61], v[44:45], v[72:73], v[60:61] op_sel:[0,0,0] op_sel_hi:[1,0,1] neg_lo:[0,0,1] neg_hi:[0,0,1]
    v_pk_fma_f32 v[68:69], v[52:53], v[72:73], v[68:69] op_sel:[0,0,0] op_sel_hi:[1,0,1] neg_lo:[0,0,1] neg_hi:[0,0,1]
    v_pk_fma_f32 v[62:63], v[46:47], v[72:73], v[62:63] op_sel:[0,0,0] op_sel_hi:[1,0,1] neg_lo:[0,0,1] neg_hi:[0,0,1]
    v_pk_fma_f32 v[70:71], v[54:55], v[72:73], v[70:71] op_sel:[0,0,0] op_sel_hi:[1,0,1] neg_lo:[0,0,1] neg_hi:[0,0,1]
    v_cvt_pk_bf16_f32 v164, v40, v41
    v_cvt_pk_bf16_f32 v168, -v48, -v49
    v_cvt_pk_bf16_f32 v165, v42, v43
    v_cvt_pk_bf16_f32 v169, -v50, -v51
    v_cvt_pk_bf16_f32 v166, v44, v45
    v_cvt_pk_bf16_f32 v170, -v52, -v53
    v_cvt_pk_bf16_f32 v167, v46, v47
    v_cvt_pk_bf16_f32 v171, -v54, -v55
    v_pk_fma_f32 v[40:41], v[56:57], v[72:73], v[40:41] op_sel:[0,0,0] op_sel_hi:[1,0,1] neg_lo:[0,0,1] neg_hi:[0,0,1]
    v_pk_fma_f32 v[48:49], v[64:65], v[72:73], v[48:49] op_sel:[0,0,0] op_sel_hi:[1,0,1] neg_lo:[0,0,1] neg_hi:[0,0,1]
    v_pk_fma_f32 v[42:43], v[58:59], v[72:73], v[42:43] op_sel:[0,0,0] op_sel_hi:[1,0,1] neg_lo:[0,0,1] neg_hi:[0,0,1]
    v_pk_fma_f32 v[50:51], v[66:67], v[72:73], v[50:51] op_sel:[0,0,0] op_sel_hi:[1,0,1] neg_lo:[0,0,1] neg_hi:[0,0,1]
    v_pk_fma_f32 v[44:45], v[60:61], v[72:73], v[44:45] op_sel:[0,0,0] op_sel_hi:[1,0,1] neg_lo:[0,0,1] neg_hi:[0,0,1]
    v_pk_fma_f32 v[52:53], v[68:69], v[72:73], v[52:53] op_sel:[0,0,0] op_sel_hi:[1,0,1] neg_lo:[0,0,1] neg_hi:[0,0,1]
    v_pk_fma_f32 v[46:47], v[62:63], v[72:73], v[46:47] op_sel:[0,0,0] op_sel_hi:[1,0,1] neg_lo:[0,0,1] neg_hi:[0,0,1]
    v_pk_fma_f32 v[54:55], v[70:71], v[72:73], v[54:55] op_sel:[0,0,0] op_sel_hi:[1,0,1] neg_lo:[0,0,1] neg_hi:[0,0,1]
    v_cvt_pk_bf16_f32 v172, v56, v57
    v_cvt_pk_bf16_f32 v176, -v64, -v65
    v_cvt_pk_bf16_f32 v173, v58, v59
    v_cvt_pk_bf16_f32 v177, -v66, -v67
    v_cvt_pk_bf16_f32 v174, v60, v61
    v_cvt_pk_bf16_f32 v178, -v68, -v69
    v_cvt_pk_bf16_f32 v175, v62, v63
    v_cvt_pk_bf16_f32 v179, -v70, -v71
    v_pk_fma_f32 v[56:57], v[40:41], v[72:73], v[56:57] op_sel:[0,0,0] op_sel_hi:[1,0,1] neg_lo:[0,0,1] neg_hi:[0,0,1]
    v_pk_fma_f32 v[64:65], v[48:49], v[72:73], v[64:65] op_sel:[0,0,0] op_sel_hi:[1,0,1] neg_lo:[0,0,1] neg_hi:[0,0,1]
    v_pk_fma_f32 v[58:59], v[42:43], v[72:73], v[58:59] op_sel:[0,0,0] op_sel_hi:[1,0,1] neg_lo:[0,0,1] neg_hi:[0,0,1]
    v_pk_fma_f32 v[66:67], v[50:51], v[72:73], v[66:67] op_sel:[0,0,0] op_sel_hi:[1,0,1] neg_lo:[0,0,1] neg_hi:[0,0,1]
    v_pk_fma_f32 v[60:61], v[44:45], v[72:73], v[60:61] op_sel:[0,0,0] op_sel_hi:[1,0,1] neg_lo:[0,0,1] neg_hi:[0,0,1]
    v_pk_fma_f32 v[68:69], v[52:53], v[72:73], v[68:69] op_sel:[0,0,0] op_sel_hi:[1,0,1] neg_lo:[0,0,1] neg_hi:[0,0,1]
    v_pk_fma_f32 v[62:63], v[46:47], v[72:73], v[62:63] op_sel:[0,0,0] op_sel_hi:[1,0,1] neg_lo:[0,0,1] neg_hi:[0,0,1]
    v_pk_fma_f32 v[70:71], v[54:55], v[72:73], v[70:71] op_sel:[0,0,0] op_sel_hi:[1,0,1] neg_lo:[0,0,1] neg_hi:[0,0,1]
    v_cvt_pk_bf16_f32 v180, v40, v41
    v_cvt_pk_bf16_f32 v184, -v48, -v49
    v_cvt_pk_bf16_f32 v181, v42, v43
    v_cvt_pk_bf16_f32 v185, -v50, -v51
    v_cvt_pk_bf16_f32 v182, v44, v45
    v_cvt_pk_bf16_f32 v186, -v52, -v53
    v_cvt_pk_bf16_f32 v183, v46, v47
    v_cvt_pk_bf16_f32 v187, -v54, -v55
    v_pk_fma_f32 v[40:41], v[56:57], v[72:73], v[40:41] op_sel:[0,0,0] op_sel_hi:[1,0,1] neg_lo:[0,0,1] neg_hi:[0,0,1]
    v_pk_fma_f32 v[48:49], v[64:65], v[72:73], v[48:49] op_sel:[0,0,0] op_sel_hi:[1,0,1] neg_lo:[0,0,1] neg_hi:[0,0,1]
    v_pk_fma_f32 v[42:43], v[58:59], v[72:73], v[42:43] op_sel:[0,0,0] op_sel_hi:[1,0,1] neg_lo:[0,0,1] neg_hi:[0,0,1]
    v_pk_fma_f32 v[50:51], v[66:67], v[72:73], v[50:51] op_sel:[0,0,0] op_sel_hi:[1,0,1] neg_lo:[0,0,1] neg_hi:[0,0,1]
    v_pk_fma_f32 v[44:45], v[60:61], v[72:73], v[44:45] op_sel:[0,0,0] op_sel_hi:[1,0,1] neg_lo:[0,0,1] neg_hi:[0,0,1]
    v_pk_fma_f32 v[52:53], v[68:69], v[72:73], v[52:53] op_sel:[0,0,0] op_sel_hi:[1,0,1] neg_lo:[0,0,1] neg_hi:[0,0,1]
    v_pk_fma_f32 v[46:47], v[62:63], v[72:73], v[46:47] op_sel:[0,0,0] op_sel_hi:[1,0,1] neg_lo:[0,0,1] neg_hi:[0,0,1]
    v_pk_fma_f32 v[54:55], v[70:71], v[72:73], v[54:55] op_sel:[0,0,0] op_sel_hi:[1,0,1] neg_lo:[0,0,1] neg_hi:[0,0,1]
    v_cvt_pk_bf16_f32 v188, v56, v57
    v_cvt_pk_bf16_f32 v192, -v64, -v65
    v_cvt_pk_bf16_f32 v189, v58, v59
    v_cvt_pk_bf16_f32 v193, -v66, -v67
    v_cvt_pk_bf16_f32 v190, v60, v61
    v_cvt_pk_bf16_f32 v194, -v68, -v69
    v_cvt_pk_bf16_f32 v191, v62, v63
    v_cvt_pk_bf16_f32 v195, -v70, -v71
    v_pk_fma_f32 v[56:57], v[40:41], v[72:73], v[56:57] op_sel:[0,0,0] op_sel_hi:[1,0,1] neg_lo:[0,0,1] neg_hi:[0,0,1]
    v_pk_fma_f32 v[64:65], v[48:49], v[72:73], v[64:65] op_sel:[0,0,0] op_sel_hi:[1,0,1] neg_lo:[0,0,1] neg_hi:[0,0,1]
    v_pk_fma_f32 v[58:59], v[42:43], v[72:73], v[58:59] op_sel:[0,0,0] op_sel_hi:[1,0,1] neg_lo:[0,0,1] neg_hi:[0,0,1]
    v_pk_fma_f32 v[66:67], v[50:51], v[72:73], v[66:67] op_sel:[0,0,0] op_sel_hi:[1,0,1] neg_lo:[0,0,1] neg_hi:[0,0,1]
    v_pk_fma_f32 v[60:61], v[44:45], v[72:73], v[60:61] op_sel:[0,0,0] op_sel_hi:[1,0,1] neg_lo:[0,0,1] neg_hi:[0,0,1]
    v_pk_fma_f32 v[68:69], v[52:53], v[72:73], v[68:69] op_sel:[0,0,0] op_sel_hi:[1,0,1] neg_lo:[0,0,1] neg_hi:[0,0,1]
    v_pk_fma_f32 v[62:63], v[46:47], v[72:73], v[62:63] op_sel:[0,0,0] op_sel_hi:[1,0,1] neg_lo:[0,0,1] neg_hi:[0,0,1]
    v_pk_fma_f32 v[70:71], v[54:55], v[72:73], v[70:71] op_sel:[0,0,0] op_sel_hi:[1,0,1] neg_lo:[0,0,1] neg_hi:[0,0,1]
    v_cvt_pk_bf16_f32 v196, v40, v41
    v_cvt_pk_bf16_f32 v200, -v48, -v49
    v_cvt_pk_bf16_f32 v197, v42, v43
    v_cvt_pk_bf16_f32 v201, -v50, -v51
    v_cvt_pk_bf16_f32 v198, v44, v45
    v_cvt_pk_bf16_f32 v202, -v52, -v53
    v_cvt_pk_bf16_f32 v199, v46, v47
    v_cvt_pk_bf16_f32 v203, -v54, -v55
    v_cvt_pk_bf16_f32 v204, v56, v57
    v_cvt_pk_bf16_f32 v208, -v64, -v65
    v_cvt_pk_bf16_f32 v205, v58, v59
    v_cvt_pk_bf16_f32 v209, -v66, -v67
    v_cvt_pk_bf16_f32 v206, v60, v61
    v_cvt_pk_bf16_f32 v210, -v68, -v69
    v_cvt_pk_bf16_f32 v207, v62, v63
    v_cvt_pk_bf16_f32 v211, -v70, -v71
    v_and_b32 v36, 15, v0
    v_lshrrev_b32 v37, 2, v36
    v_and_b32 v36, 3, v36
    v_lshl_add_u32 v36, v37, 3, v36
    v_mul_u32_u24 v36, 928, v36
    v_lshl_add_u32 v36, v5, 1, v36
    v_mul_u32_u24 v37, 8448, v4
    v_lshl_add_u32 v37, v5, 1, v37
    v_add_u32 v38, 4224, v37
    s_add_u32 s44, s34, 0x200000
    s_addc_u32 s45, s35, 0
    s_mov_b32 s46, 0x1d0100
    s_mov_b32 s47, 0x00020000
    s_cmp_lt_u32 s2, 72
    s_cbranch_scc1 L_k0_w1
    s_waitcnt vmcnt(0)
L_k0_w1:
    s_waitcnt vmcnt(1)
L_k0_ln:
    v_lshlrev_b32 v40, 16, v8
    v_and_b32 v41, 0xffff0000, v8
    v_lshlrev_b32 v42, 16, v9
    v_and_b32 v43, 0xffff0000, v9
    v_lshlrev_b32 v44, 16, v10
    v_and_b32 v45, 0xffff0000, v10
    v_lshlrev_b32 v46, 16, v11
    v_and_b32 v47, 0xffff0000, v11
    v_lshlrev_b32 v48, 16, v12
    v_and_b32 v49, 0xffff0000, v12
    v_lshlrev_b32 v50, 16, v13
    v_and_b32 v51, 0xffff0000, v13
    v_lshlrev_b32 v52, 16, v14
    v_and_b32 v53, 0xffff0000, v14
    v_lshlrev_b32 v54, 16, v15
    v_and_b32 v55, 0xffff0000, v15
    v_lshlrev_b32 v56, 16, v16
    v_and_b32 v57, 0xffff0000, v16
    v_lshlrev_b32 v58, 16, v17
    v_and_b32 v59, 0xffff0000, v17
    v_lshlrev_b32 v60, 16, v18
    v_and_b32 v61, 0xffff0000, v18
    v_lshlrev_b32 v62, 16, v19
    v_and_b32 v63, 0xffff0000, v19
    v_lshlrev_b32 v64, 16, v20
    v_and_b32 v65, 0xffff0000, v20
    v_lshlrev_b32 v66, 16, v21
    v_and_b32 v67, 0xffff0000, v21
    v_pk_add_f32 v[72:73], v[40:41], v[44:45]
    v_pk_add_f32 v[74:75], v[42:43], v[46:47]
    v_pk_add_f32 v[72:73], v[72:73], v[48:49]
    v_pk_add_f32 v[74:75], v[74:75], v[50:51]
    v_pk_add_f32 v[72:73], v[72:73], v[52:53]
    v_pk_add_f32 v[74:75], v[74:75], v[54:55]
    v_pk_add_f32 v[72:73], v[72:73], v[56:57]
    v_pk_add_f32 v[74:75], v[74:75], v[58:59]
    v_pk_add_f32 v[72:73], v[72:73], v[60:61]
    v_pk_add_f32 v[74:75], v[74:75], v[62:63]
    v_pk_add_f32 v[72:73], v[72:73], v[64:65]
    v_pk_add_f32 v[74:75], v[74:75], v[66:67]
    v_pk_add_f32 v[72:73], v[72:73], v[74:75]
    v_add_f32 v72, v72, v73
    s_nop 1
    v_add_f32_dpp v72, v72, v72 quad_perm:[1,0,3,2] row_mask:0xf bank_mask:0xf
    s_nop 1
    v_add_f32_dpp v72, v72, v72 quad_perm:[2,3,0,1] row_mask:0xf bank_mask:0xf
    s_nop 1
    v_add_f32_dpp v72, v72, v72 row_half_mirror row_mask:0xf bank_mask:0xf
    s_nop 1
    v_add_f32_dpp v72, v72, v72 row_mirror row_mask:0xf bank_mask:0xf
    v_mul_f32 v76, s7, v72
    v_pk_add_f32 v[80:81], v[40:41], v[76:77] op_sel_hi:[1,0] neg_lo:[0,1] neg_hi:[0,1]
    v_pk_mul_f32 v[72:73], v[80:81], v[80:81]
    v_pk_add_f32 v[82:83], v[42:43], v[76:77] op_sel_hi:[1,0] neg_lo:[0,1] neg_hi:[0,1]
    v_pk_mul_f32 v[74:75], v[82:83], v[82:83]
    v_pk_add_f32 v[84:85], v[44:45], v[76:77] op_sel_hi:[1,0] neg_lo:[0,1] neg_hi:[0,1]
    v_pk_fma_f32 v[72:73], v[84:85], v[84:85], v[72:73]
    v_pk_add_f32 v[86:87], v[46:47], v[76:77] op_sel_hi:[1,0] neg_lo:[0,1] neg_hi:[0,1]
    v_pk_fma_f32 v[74:75], v[86:87], v[86:87], v[74:75]
    v_pk_add_f32 v[80:81], v[48:49], v[76:77] op_sel_hi:[1,0] neg_lo:[0,1] neg_hi:[0,1]
    v_pk_fma_f32 v[72:73], v[80:81], v[80:81], v[72:73]
    v_pk_add_f32 v[82:83], v[50:51], v[76:77] op_sel_hi:[1,0] neg_lo:[0,1] neg_hi:[0,1]
    v_pk_fma_f32 v[74:75], v[82:83], v[82:83], v[74:75]
    v_pk_add_f32 v[84:85], v[52:53], v[76:77] op_sel_hi:[1,0] neg_lo:[0,1] neg_hi:[0,1]
    v_pk_fma_f32 v[72:73], v[84:85], v[84:85], v[72:73]
    v_pk_add_f32 v[86:87], v[54:55], v[76:77] op_sel_hi:[1,0] neg_lo:[0,1] neg_hi:[0,1]
    v_pk_fma_f32 v[74:75], v[86:87], v[86:87], v[74:75]
    v_pk_add_f32 v[80:81], v[56:57], v[76:77] op_sel_hi:[1,0] neg_lo:[0,1] neg_hi:[0,1]
    v_pk_fma_f32 v[72:73], v[80:81], v[80:81], v[72:73]
    v_pk_add_f32 v[82:83], v[58:59], v[76:77] op_sel_hi:[1,0] neg_lo:[0,1] neg_hi:[0,1]
    v_pk_fma_f32 v[74:75], v[82:83], v[82:83], v[74:75]
    v_pk_add_f32 v[84:85], v[60:61], v[76:77] op_sel_hi:[1,0] neg_lo:[0,1] neg_hi:[0,1]
    v_pk_fma_f32 v[72:73], v[84:85], v[84:85], v[72:73]
    v_pk_add_f32 v[86:87], v[62:63], v[76:77] op_sel_hi:[1,0] neg_lo:[0,1] neg_hi:[0,1]
    v_pk_fma_f32 v[74:75], v[86:87], v[86:87], v[74:75]
    v_pk_add_f32 v[80:81], v[64:65], v[76:77] op_sel_hi:[1,0] neg_lo:[0,1] neg_hi:[0,1]
    v_pk_fma_f32 v[72:73], v[80:81], v[80:81], v[72:73]
    v_pk_add_f32 v[82:83], v[66:67], v[76:77] op_sel_hi:[1,0] neg_lo:[0,1] neg_hi:[0,1]
    v_pk_fma_f32 v[74:75], v[82:83], v[82:83], v[74:75]
    v_pk_add_f32 v[72:73], v[72:73], v[74:75]
    v_add_f32 v72, v72, v73
    s_nop 1
    v_add_f32_dpp v72, v72, v72 quad_perm:[1,0,3,2] row_mask:0xf bank_mask:0xf
    s_nop 1
    v_add_f32_dpp v72, v72, v72 quad_perm:[2,3,0,1] row_mask:0xf bank_mask:0xf
    s_nop 1
    v_add_f32_dpp v72, v72, v72 row_half_mirror row_mask:0xf bank_mask:0xf
    s_nop 1
    v_add_f32_dpp v72, v72, v72 row_mirror row_mask:0xf bank_mask:0xf
    v_mul_f32 v72, s7, v72
    v_cvt_pk_bf16_f32 v74, v76, v72
    v_lshlrev_b32 v76, 16, v74
    v_and_b32 v72, 0xffff0000, v74
    v_add_f32 v72, 0x3727c5ac, v72
    v_cvt_pk_bf16_f32 v72, v72, v72
    v_lshlrev_b32 v72, 16, v72
    v_sqrt_f32 v72, v72
    s_nop 0
    v_cvt_pk_bf16_f32 v72, v72, v72
    v_lshlrev_b32 v72, 16, v72
    v_rcp_f32 v78, v72
    s_nop 0
    v_pk_add_f32 v[40:41], v[40:41], v[76:77] op_sel_hi:[1,0] neg_lo:[0,1] neg_hi:[0,1]
    v_cvt_pk_bf16_f32 v75, v40, v41
    v_lshlrev_b32 v40, 16, v75
    v_and_b32 v41, 0xffff0000, v75
    v_pk_mul_f32 v[40:41], v[40:41], v[78:79] op_sel_hi:[1,0]
    v_cvt_pk_bf16_f32 v8, v40, v41
    v_pk_add_f32 v[42:43], v[42:43], v[76:77] op_sel_hi:[1,0] neg_lo:[0,1] neg_hi:[0,1]
    v_cvt_pk_bf16_f32 v75, v42, v43
    v_lshlrev_b32 v42, 16, v75
    v_and_b32 v43, 0xffff0000, v75
    v_pk_mul_f32 v[42:43], v[42:43], v[78:79] op_sel_hi:[1,0]
    v_cvt_pk_bf16_f32 v9, v42, v43
    v_pk_add_f32 v[44:45], v[44:45], v[76:77] op_sel_hi:[1,0] neg_lo:[0,1] neg_hi:[0,1]
    v_cvt_pk_bf16_f32 v75, v44, v45
    v_lshlrev_b32 v44, 16, v75
    v_and_b32 v45, 0xffff0000, v75
    v_pk_mul_f32 v[44:45], v[44:45], v[78:79] op_sel_hi:[1,0]
    v_cvt_pk_bf16_f32 v10, v44, v45
    v_pk_add_f32 v[46:47], v[46:47], v[76:77] op_sel_hi:[1,0] neg_lo:[0,1] neg_hi:[0,1]
    v_cvt_pk_bf16_f32 v75, v46, v47
    v_lshlrev_b32 v46, 16, v75
    v_and_b32 v47, 0xffff0000, v75
    v_pk_mul_f32 v[46:47], v[46:47], v[78:79] op_sel_hi:[1,0]
    v_cvt_pk_bf16_f32 v11, v46, v47
    v_pk_add_f32 v[48:49], v[48:49], v[76:77] op_sel_hi:[1,0] neg_lo:[0,1] neg_hi:[0,1]
    v_cvt_pk_bf16_f32 v75, v48, v49
    v_lshlrev_b32 v48, 16, v75
    v_and_b32 v49, 0xffff0000, v75
    v_pk_mul_f32 v[48:49], v[48:49], v[78:79] op_sel_hi:[1,0]
    v_cvt_pk_bf16_f32 v12, v48, v49
    v_pk_add_f32 v[50:51], v[50:51], v[76:77] op_sel_hi:[1,0] neg_lo:[0,1] neg_hi:[0,1]
    v_cvt_pk_bf16_f32 v75, v50, v51
    v_lshlrev_b32 v50, 16, v75
    v_and_b32 v51, 0xffff0000, v75
    v_pk_mul_f32 v[50:51], v[50:51], v[78:79] op_sel_hi:[1,0]
    v_cvt_pk_bf16_f32 v13, v50, v51
    v_pk_add_f32 v[52:53], v[52:53], v[76:77] op_sel_hi:[1,0] neg_lo:[0,1] neg_hi:[0,1]
    v_cvt_pk_bf16_f32 v75, v52, v53
    v_lshlrev_b32 v52, 16, v75
    v_and_b32 v53, 0xffff0000, v75
    v_pk_mul_f32 v[52:53], v[52:53], v[78:79] op_sel_hi:[1,0]
    v_cvt_pk_bf16_f32 v14, v52, v53
    v_pk_add_f32 v[54:55], v[54:55], v[76:77] op_sel_hi:[1,0] neg_lo:[0,1] neg_hi:[0,1]
    v_cvt_pk_bf16_f32 v75, v54, v55
    v_lshlrev_b32 v54, 16, v75
    v_and_b32 v55, 0xffff0000, v75
    v_pk_mul_f32 v[54:55], v[54:55], v[78:79] op_sel_hi:[1,0]
    v_cvt_pk_bf16_f32 v15, v54, v55
    v_pk_add_f32 v[56:57], v[56:57], v[76:77] op_sel_hi:[1,0] neg_lo:[0,1] neg_hi:[0,1]
    v_cvt_pk_bf16_f32 v75, v56, v57
    v_lshlrev_b32 v56, 16, v75
    v_and_b32 v57, 0xffff0000, v75
    v_pk_mul_f32 v[56:57], v[56:57], v[78:79] op_sel_hi:[1,0]
    v_cvt_pk_bf16_f32 v16, v56, v57
    v_pk_add_f32 v[58:59], v[58:59], v[76:77] op_sel_hi:[1,0] neg_lo:[0,1] neg_hi:[0,1]
    v_cvt_pk_bf16_f32 v75, v58, v59
    v_lshlrev_b32 v58, 16, v75
    v_and_b32 v59, 0xffff0000, v75
    v_pk_mul_f32 v[58:59], v[58:59], v[78:79] op_sel_hi:[1,0]
    v_cvt_pk_bf16_f32 v17, v58, v59
    v_pk_add_f32 v[60:61], v[60:61], v[76:77] op_sel_hi:[1,0] neg_lo:[0,1] neg_hi:[0,1]
    v_cvt_pk_bf16_f32 v75, v60, v61
    v_lshlrev_b32 v60, 16, v75
    v_and_b32 v61, 0xffff0000, v75
    v_pk_mul_f32 v[60:61], v[60:61], v[78:79] op_sel_hi:[1,0]
    v_cvt_pk_bf16_f32 v18, v60, v61
    v_pk_add_f32 v[62:63], v[62:63], v[76:77] op_sel_hi:[1,0] neg_lo:[0,1] neg_hi:[0,1]
    v_cvt_pk_bf16_f32 v75, v62, v63
    v_lshlrev_b32 v62, 16, v75
    v_and_b32 v63, 0xffff0000, v75
    v_pk_mul_f32 v[62:63], v[62:63], v[78:79] op_sel_hi:[1,0]
    v_cvt_pk_bf16_f32 v19, v62, v63
    v_pk_add_f32 v[64:65], v[64:65], v[76:77] op_sel_hi:[1,0] neg_lo:[0,1] neg_hi:[0,1]
    v_cvt_pk_bf16_f32 v75, v64, v65
    v_lshlrev_b32 v64, 16, v75
    v_and_b32 v65, 0xffff0000, v75
    v_pk_mul_f32 v[64:65], v[64:65], v[78:79] op_sel_hi:[1,0]
    v_cvt_pk_bf16_f32 v20, v64, v65
    v_pk_add_f32 v[66:67], v[66:67], v[76:77] op_sel_hi:[1,0] neg_lo:[0,1] neg_hi:[0,1]
    v_cvt_pk_bf16_f32 v75, v66, v67
    v_lshlrev_b32 v66, 16, v75
    v_and_b32 v67, 0xffff0000, v75
    v_pk_mul_f32 v[66:67], v[66:67], v[78:79] op_sel_hi:[1,0]
    v_cvt_pk_bf16_f32 v21, v66, v67
    v_mul_u32_u24 v74, 928, v1
    v_lshl_add_u32 v74, v2, 3, v74
    ds_write_b64 v74, v[8:9] offset:0
    ds_write_b64 v74, v[10:11] offset:128
    ds_write_b64 v74, v[12:13] offset:256
    ds_write_b64 v74, v[14:15] offset:384
    ds_write_b64 v74, v[16:17] offset:512
    ds_write_b64 v74, v[18:19] offset:640
    ds_write_b64 v74, v[20:21] offset:768
    s_cmp_ge_u32 s6, 4
    s_cbranch_scc1 L_k0_noxne
    s_cmp_ge_u32 s4, 2
    s_cbranch_scc1 L_k0_xnhie
    buffer_store_dwordx2 v[8:9], v3, s[40:43], s5 offen offset:0
    buffer_store_dwordx2 v[10:11], v3, s[40:43], s5 offen offset:128
    buffer_store_dwordx2 v[12:13], v3, s[40:43], s5 offen offset:256
    buffer_store_dwordx2 v[14:15], v3, s[40:43], s5 offen offset:384
    s_branch L_k0_noxne
L_k0_xnhie:
    buffer_store_dwordx2 v[16:17], v3, s[40:43], s5 offen offset:512
    buffer_store_dwordx2 v[18:19], v3, s[40:43], s5 offen offset:640
    buffer_store_dwordx2 v[20:21], v3, s[40:43], s5 offen offset:768
L_k0_noxne:
    s_waitcnt lgkmcnt(0)
    s_barrier
    s_cmp_ge_u32 s6, 4
    s_cbranch_scc1 L_k0_mfma
    s_waitcnt vmcnt(9)
    v_cmp_gt_u32 vcc, 225, v0
    s_and_saveexec_b64 s[10:11], vcc
    s_cbranch_execz L_k0_wt_restore
    v_mul_u32_u24 v36, 8448, v0
    v_lshl_or_b32 v128, v113, 16, v112
    v_lshl_or_b32 v129, v115, 16, v114
    v_lshl_or_b32 v130, v117, 16, v116
    v_lshl_or_b32 v131, v119, 16, v118
    v_lshl_or_b32 v132, v121, 16, v120
    v_lshl_or_b32 v133, v123, 16, v122
    v_lshl_or_b32 v134, v125, 16, v124
    v_lshl_or_b32 v135, v127, 16, v126
    s_lshl_b32 s8, s3, 6
    s_lshl_b32 s9, s4, 4
    s_add_u32 s8, s8, s9
    s_add_u32 s9, s8, 4224
    buffer_store_dwordx4 v[128:131], v36, s[60:63], s8 offen
    buffer_store_dwordx4 v[132:135], v36, s[60:63], s9 offen
L_k0_wt_restore:
    s_mov_b64 exec, s[10:11]
    s_endpgm
L_k0_mfma:
    s_lshl_b32 s6, s3, 6
    ds_read_b128 v[40:43], v36 offset:0
    ds_read_b128 v[44:47], v36 offset:3712
    ds_read_b128 v[48:51], v36 offset:64
    ds_read_b128 v[52:55], v36 offset:3776
    ds_read_b128 v[56:59], v36 offset:128
    ds_read_b128 v[60:63], v36 offset:3840
    s_waitcnt lgkmcnt(4)
    v_mfma_f32_16x16x32_bf16 v[80:83], v[40:43], v[100:103], 0
    v_mfma_f32_16x16x32_bf16 v[84:87], v[40:43], v[104:107], 0
    v_mfma_f32_16x16x32_bf16 v[88:91], v[44:47], v[100:103], 0
    v_mfma_f32_16x16x32_bf16 v[92:95], v[44:47], v[104:107], 0
    ds_read_b128 v[40:43], v36 offset:192
    ds_read_b128 v[44:47], v36 offset:3904
    s_waitcnt lgkmcnt(4)
    v_mfma_f32_16x16x32_bf16 v[80:83], v[48:51], v[108:111], v[80:83]
    v_mfma_f32_16x16x32_bf16 v[84:87], v[48:51], v[112:115], v[84:87]
    v_mfma_f32_16x16x32_bf16 v[88:91], v[52:55], v[108:111], v[88:91]
    v_mfma_f32_16x16x32_bf16 v[92:95], v[52:55], v[112:115], v[92:95]
    ds_read_b128 v[48:51], v36 offset:256
    ds_read_b128 v[52:55], v36 offset:3968
    s_waitcnt lgkmcnt(4)
    v_mfma_f32_16x16x32_bf16 v[80:83], v[56:59], v[116:119], v[80:83]
    v_mfma_f32_16x16x32_bf16 v[84:87], v[56:59], v[120:123], v[84:87]
    v_mfma_f32_16x16x32_bf16 v[88:91], v[60:63], v[116:119], v[88:91]
    v_mfma_f32_16x16x32_bf16 v[92:95], v[60:63], v[120:123], v[92:95]
    ds_read_b128 v[56:59], v36 offset:320
    ds_read_b128 v[60:63], v36 offset:4032
    s_waitcnt lgkmcnt(4)
    v_mfma_f32_16x16x32_bf16 v[80:83], v[40:43], v[124:127], v[80:83]
    v_mfma_f32_16x16x32_bf16 v[84:87], v[40:43], v[128:131], v[84:87]
    v_mfma_f32_16x16x32_bf16 v[88:91], v[44:47], v[124:127], v[88:91]
    v_mfma_f32_16x16x32_bf16 v[92:95], v[44:47], v[128:131], v[92:95]
    ds_read_b128 v[40:43], v36 offset:384
    ds_read_b128 v[44:47], v36 offset:4096
    s_waitcnt lgkmcnt(4)
    v_mfma_f32_16x16x32_bf16 v[80:83], v[48:51], v[132:135], v[80:83]
    v_mfma_f32_16x16x32_bf16 v[84:87], v[48:51], v[136:139], v[84:87]
    v_mfma_f32_16x16x32_bf16 v[88:91], v[52:55], v[132:135], v[88:91]
    v_mfma_f32_16x16x32_bf16 v[92:95], v[52:55], v[136:139], v[92:95]
    ds_read_b128 v[48:51], v36 offset:448
    ds_read_b128 v[52:55], v36 offset:4160
    s_waitcnt lgkmcnt(4)
    v_mfma_f32_16x16x32_bf16 v[80:83], v[56:59], v[140:143], v[80:83]
    v_mfma_f32_16x16x32_bf16 v[84:87], v[56:59], v[144:147], v[84:87]
    v_mfma_f32_16x16x32_bf16 v[88:91], v[60:63], v[140:143], v[88:91]
    v_mfma_f32_16x16x32_bf16 v[92:95], v[60:63], v[144:147], v[92:95]
    ds_read_b128 v[56:59], v36 offset:512
    ds_read_b128 v[60:63], v36 offset:4224
    s_waitcnt lgkmcnt(4)
    v_mfma_f32_16x16x32_bf16 v[80:83], v[40:43], v[148:151], v[80:83]
    v_mfma_f32_16x16x32_bf16 v[84:87], v[40:43], v[152:155], v[84:87]
    v_mfma_f32_16x16x32_bf16 v[88:91], v[44:47], v[148:151], v[88:91]
    v_mfma_f32_16x16x32_bf16 v[92:95], v[44:47], v[152:155], v[92:95]
    ds_read_b128 v[40:43], v36 offset:576
    ds_read_b128 v[44:47], v36 offset:4288
    s_waitcnt lgkmcnt(4)
    v_mfma_f32_16x16x32_bf16 v[80:83], v[48:51], v[156:159], v[80:83]
    v_mfma_f32_16x16x32_bf16 v[84:87], v[48:51], v[160:163], v[84:87]
    v_mfma_f32_16x16x32_bf16 v[88:91], v[52:55], v[156:159], v[88:91]
    v_mfma_f32_16x16x32_bf16 v[92:95], v[52:55], v[160:163], v[92:95]
    ds_read_b128 v[48:51], v36 offset:640
    ds_read_b128 v[52:55], v36 offset:4352
    s_waitcnt lgkmcnt(4)
    v_mfma_f32_16x16x32_bf16 v[80:83], v[56:59], v[164:167], v[80:83]
    v_mfma_f32_16x16x32_bf16 v[84:87], v[56:59], v[168:171], v[84:87]
    v_mfma_f32_16x16x32_bf16 v[88:91], v[60:63], v[164:167], v[88:91]
    v_mfma_f32_16x16x32_bf16 v[92:95], v[60:63], v[168:171], v[92:95]
    ds_read_b128 v[56:59], v36 offset:704
    ds_read_b128 v[60:63], v36 offset:4416
    s_waitcnt lgkmcnt(4)
    v_mfma_f32_16x16x32_bf16 v[80:83], v[40:43], v[172:175], v[80:83]
    v_mfma_f32_16x16x32_bf16 v[84:87], v[40:43], v[176:179], v[84:87]
    v_mfma_f32_16x16x32_bf16 v[88:91], v[44:47], v[172:175], v[88:91]
    v_mfma_f32_16x16x32_bf16 v[92:95], v[44:47], v[176:179], v[92:95]
    ds_read_b128 v[40:43], v36 offset:768
    ds_read_b128 v[44:47], v36 offset:4480
    s_waitcnt lgkmcnt(4)
    v_mfma_f32_16x16x32_bf16 v[80:83], v[48:51], v[180:183], v[80:83]
    v_mfma_f32_16x16x32_bf16 v[84:87], v[48:51], v[184:187], v[84:87]
    v_mfma_f32_16x16x32_bf16 v[88:91], v[52:55], v[180:183], v[88:91]
    v_mfma_f32_16x16x32_bf16 v[92:95], v[52:55], v[184:187], v[92:95]
    ds_read_b128 v[48:51], v36 offset:832
    ds_read_b128 v[52:55], v36 offset:4544
    s_waitcnt lgkmcnt(4)
    v_mfma_f32_16x16x32_bf16 v[80:83], v[56:59], v[188:191], v[80:83]
    v_mfma_f32_16x16x32_bf16 v[84:87], v[56:59], v[192:195], v[84:87]
    v_mfma_f32_16x16x32_bf16 v[88:91], v[60:63], v[188:191], v[88:91]
    v_mfma_f32_16x16x32_bf16 v[92:95], v[60:63], v[192:195], v[92:95]
    s_waitcnt lgkmcnt(2)
    v_mfma_f32_16x16x32_bf16 v[80:83], v[40:43], v[196:199], v[80:83]
    v_mfma_f32_16x16x32_bf16 v[84:87], v[40:43], v[200:203], v[84:87]
    v_mfma_f32_16x16x32_bf16 v[88:91], v[44:47], v[196:199], v[88:91]
    v_mfma_f32_16x16x32_bf16 v[92:95], v[44:47], v[200:203], v[92:95]
    s_waitcnt lgkmcnt(0)
    v_mfma_f32_16x16x32_bf16 v[80:83], v[48:51], v[204:207], v[80:83]
    v_mfma_f32_16x16x32_bf16 v[84:87], v[48:51], v[208:211], v[84:87]
    v_mfma_f32_16x16x32_bf16 v[88:91], v[52:55], v[204:207], v[88:91]
    v_mfma_f32_16x16x32_bf16 v[92:95], v[52:55], v[208:211], v[92:95]
    s_nop 9
    v_cvt_pk_bf16_f32 v64, v80, v81
    v_cvt_pk_bf16_f32 v65, v82, v83
    v_cvt_pk_bf16_f32 v66, v88, v89
    v_cvt_pk_bf16_f32 v67, v90, v91
    buffer_store_dwordx4 v[64:67], v37, s[44:47], s6 offen
    v_cvt_pk_bf16_f32 v68, v84, v85
    v_cvt_pk_bf16_f32 v69, v86, v87
    v_cvt_pk_bf16_f32 v70, v92, v93
    v_cvt_pk_bf16_f32 v71, v94, v95
    buffer_store_dwordx4 v[68:71], v38, s[44:47], s6 offen
L_k0_end:
    s_endpgm
.globl k1_kernel
.p2align 8
.type k1_kernel,@function
k1_kernel:
    s_cmp_ge_u32 s2, 256
    s_cbranch_scc1 L_k1_end
    s_load_dwordx16 s[16:31], s[0:1], 0
    s_load_dwordx4 s[32:35], s[0:1], 64
    v_lshrrev_b32 v1, 6, v0
    v_and_b32 v2, 63, v0
    v_readfirstlane_b32 s3, v1
    s_cmp_ge_u32 s2, 32
    s_cbranch_scc1 L_k1_gemm
    s_mov_b32 s4, s2
    s_waitcnt lgkmcnt(0)
    v_and_b32 v6, 15, v0
    v_bfe_u32 v1, v0, 6, 2
    v_lshl_add_u32 v4, v1, 4, v6
    v_bfe_u32 v5, v0, 4, 2
    v_and_b32 v2, 255, v0
    v_bfe_u32 v3, v0, 5, 1
    v_lshlrev_b32 v3, 1, v3
    v_xor_b32 v2, v2, v3
    v_lshlrev_b32 v2, 4, v2
    s_lshr_b32 s66, s3, 2
    s_lshl_b32 s64, s4, 1
    s_add_u32 s64, s64, s66
    s_mul_i32 s65, s66, 69632
    s_and_b32 s67, s3, 3
    s_lshl_b32 s67, s67, 10
    s_add_u32 s67, s67, s65
    s_add_u32 s52, s34, 0x200000
    s_addc_u32 s53, s35, 0
    s_mov_b32 s54, 0x1d0100
    s_mov_b32 s55, 0x00020000
    s_add_u32 s56, s34, 0x440000
    s_addc_u32 s57, s35, 0
    s_mov_b32 s58, 0x1d0100
    s_mov_b32 s59, 0x00020000
    s_add_u32 s60, s34, 0x1000000
    s_addc_u32 s61, s35, 0
    s_mov_b32 s62, 0x1d0100
    s_mov_b32 s63, 0x00020000
    v_lshlrev_b32 v3, 6, v4
    v_lshl_add_u32 v3, v5, 3, v3
    s_add_u32 s71, s64, 0
    s_mul_i32 s71, s71, 8448
    s_add_u32 s66, s67, 0
    s_mov_b32 m0, s66
    s_add_u32 s72, s71, 4224
    buffer_load_dwordx4 v2, s[52:55], s71 offen lds
    s_add_u32 s66, s66, 4096
    s_mov_b32 m0, s66
    s_nop 0
    buffer_load_dwordx4 v2, s[52:55], s72 offen lds
    s_add_u32 s71, s64, 64
    s_mul_i32 s71, s71, 8448
    s_add_u32 s66, s67, 8192
    s_mov_b32 m0, s66
    s_add_u32 s72, s71, 4224
    buffer_load_dwordx4 v2, s[52:55], s71 offen lds
    s_add_u32 s66, s66, 4096
    s_mov_b32 m0, s66
    s_nop 0
    buffer_load_dwordx4 v2, s[52:55], s72 offen lds
    s_mov_b32 s68, 0x3c800000
    s_mov_b32 s69, 0x3d000000
    s_mov_b32 s70, 0x3a000000
    v_lshlrev_b32 v7, 3, v5
    v_mul_u32_u24 v152, v7, v4
    v_add_u32 v153, v152, v4
    v_lshlrev_b32 v154, 1, v4
    v_lshlrev_b32 v155, 2, v4
    v_and_b32 v152, 63, v152
    v_and_b32 v153, 63, v153
    v_and_b32 v154, 63, v154
    v_and_b32 v155, 63, v155
    v_cvt_f32_u32 v156, v152
    v_mul_f32 v156, s68, v156
    v_cos_f32 v96, v156
    v_sin_f32 v104, v156
    v_cvt_f32_u32 v157, v153
    v_mul_f32 v157, s68, v157
    v_cos_f32 v97, v157
    v_sin_f32 v105, v157
    v_cvt_f32_u32 v158, v154
    v_mul_f32 v158, s68, v158
    v_cos_f32 v120, v158
    v_sin_f32 v121, v158
    v_cvt_f32_u32 v159, v155
    v_mul_f32 v159, s68, v159
    v_cos_f32 v122, v159
    v_sin_f32 v123, v159
    v_lshlrev_b32 v7, 2, v5
    v_mul_u32_u24 v152, v7, v6
    v_add_u32 v153, v152, v6
    v_lshlrev_b32 v154, 1, v6
    v_and_b32 v152, 31, v152
    v_and_b32 v153, 31, v153
    v_and_b32 v154, 31, v154
    v_cvt_f32_u32 v156, v152
    v_mul_f32 v156, s69, v156
    v_cos_f32 v112, v156
    v_sin_f32 v116, v156
    v_cvt_f32_u32 v157, v153
    v_mul_f32 v157, s69, v157
    v_cos_f32 v113, v157
    v_sin_f32 v117, v157
    v_cvt_f32_u32 v158, v154
    v_mul_f32 v158, s69, v158
    v_cos_f32 v124, v158
    v_sin_f32 v125, v158
    v_mul_u32_u24 v152, v7, v4
    v_add_u32 v153, v152, v4
    v_lshlrev_b32 v154, 1, v4
    v_lshlrev_b32 v155, 4, v4
    v_cvt_f32_u32 v156, v152
    v_mul_f32 v156, s70, v156
    v_cos_f32 v64, v156
    v_sin_f32 v72, v156
    v_cvt_f32_u32 v157, v153
    v_mul_f32 v157, s70, v157
    v_cos_f32 v65, v157
    v_sin_f32 v73, v157
    v_cvt_f32_u32 v158, v154
    v_mul_f32 v158, s70, v158
    v_cos_f32 v126, v158
    v_sin_f32 v127, v158
    v_cvt_f32_u32 v159, v155
    v_mul_f32 v159, s70, v159
    v_cos_f32 v128, v159
    v_sin_f32 v129, v159
    v_and_b32 v8, 1, v0
    v_mul_u32_u24 v8, 0x8000, v8
    v_lshl_or_b32 v8, v8, 16, v8
    v_pk_mul_f32 v[98:99], v[96:97], v[120:121] op_sel:[0,0] op_sel_hi:[1,0]
    v_pk_mul_f32 v[106:107], v[104:105], v[120:121] op_sel:[0,0] op_sel_hi:[1,0]
    v_pk_fma_f32 v[98:99], v[104:105], v[120:121], v[98:99] op_sel:[0,1,0] op_sel_hi:[1,1,1] neg_lo:[1,0,0] neg_hi:[1,0,0]
    v_pk_fma_f32 v[106:107], v[96:97], v[120:121], v[106:107] op_sel:[0,1,0] op_sel_hi:[1,1,1]
    v_pk_mul_f32 v[114:115], v[112:113], v[124:125] op_sel:[0,0] op_sel_hi:[1,0]
    v_pk_mul_f32 v[118:119], v[116:117], v[124:125] op_sel:[0,0] op_sel_hi:[1,0]
    v_pk_fma_f32 v[114:115], v[116:117], v[124:125], v[114:115] op_sel:[0,1,0] op_sel_hi:[1,1,1] neg_lo:[1,0,0] neg_hi:[1,0,0]
    v_pk_fma_f32 v[118:119], v[112:113], v[124:125], v[118:119] op_sel:[0,1,0] op_sel_hi:[1,1,1]
    v_pk_mul_f32 v[66:67], v[64:65], v[126:127] op_sel:[0,0] op_sel_hi:[1,0]
    v_pk_mul_f32 v[74:75], v[72:73], v[126:127] op_sel:[0,0] op_sel_hi:[1,0]
    v_pk_fma_f32 v[66:67], v[72:73], v[126:127], v[66:67] op_sel:[0,1,0] op_sel_hi:[1,1,1] neg_lo:[1,0,0] neg_hi:[1,0,0]
    v_pk_fma_f32 v[74:75], v[64:65], v[126:127], v[74:75] op_sel:[0,1,0] op_sel_hi:[1,1,1]
    v_pk_mul_f32 v[100:101], v[96:97], v[122:123] op_sel:[0,0] op_sel_hi:[1,0]
    v_pk_mul_f32 v[108:109], v[104:105], v[122:123] op_sel:[0,0] op_sel_hi:[1,0]
    v_pk_fma_f32 v[100:101], v[104:105], v[122:123], v[100:101] op_sel:[0,1,0] op_sel_hi:[1,1,1] neg_lo:[1,0,0] neg_hi:[1,0,0]
    v_pk_fma_f32 v[108:109], v[96:97], v[122:123], v[108:109] op_sel:[0,1,0] op_sel_hi:[1,1,1]
    v_pk_mul_f32 v[102:103], v[98:99], v[122:123] op_sel:[0,0] op_sel_hi:[1,0]
    v_pk_mul_f32 v[110:111], v[106:107], v[122:123] op_sel:[0,0] op_sel_hi:[1,0]
    v_pk_fma_f32 v[102:103], v[106:107], v[122:123], v[102:103] op_sel:[0,1,0] op_sel_hi:[1,1,1] neg_lo:[1,0,0] neg_hi:[1,0,0]
    v_pk_fma_f32 v[110:111], v[98:99], v[122:123], v[110:111] op_sel:[0,1,0] op_sel_hi:[1,1,1]
    v_pk_mul_f32 v[68:69], v[64:65], v[128:129] op_sel:[0,0] op_sel_hi:[1,0]
    v_pk_mul_f32 v[76:77], v[72:73], v[128:129] op_sel:[0,0] op_sel_hi:[1,0]
    v_pk_fma_f32 v[68:69], v[72:73], v[128:129], v[68:69] op_sel:[0,1,0] op_sel_hi:[1,1,1] neg_lo:[1,0,0] neg_hi:[1,0,0]
    v_pk_fma_f32 v[76:77], v[64:65], v[128:129], v[76:77] op_sel:[0,1,0] op_sel_hi:[1,1,1]
    v_pk_mul_f32 v[70:71], v[66:67], v[128:129] op_sel:[0,0] op_sel_hi:[1,0]
    v_pk_mul_f32 v[78:79], v[74:75], v[128:129] op_sel:[0,0] op_sel_hi:[1,0]
    v_pk_fma_f32 v[70:71], v[74:75], v[128:129], v[70:71] op_sel:[0,1,0] op_sel_hi:[1,1,1] neg_lo:[1,0,0] neg_hi:[1,0,0]
    v_pk_fma_f32 v[78:79], v[66:67], v[128:129], v[78:79] op_sel:[0,1,0] op_sel_hi:[1,1,1]
    v_cvt_pk_bf16_f32 v16, v96, v97
    v_cvt_pk_bf16_f32 v24, v104, v105
    v_cvt_pk_bf16_f32 v32, -v104, -v105
    v_cvt_pk_bf16_f32 v17, v98, v99
    v_cvt_pk_bf16_f32 v25, v106, v107
    v_cvt_pk_bf16_f32 v33, -v106, -v107
    v_cvt_pk_bf16_f32 v18, v100, v101
    v_cvt_pk_bf16_f32 v26, v108, v109
    v_cvt_pk_bf16_f32 v34, -v108, -v109
    v_cvt_pk_bf16_f32 v19, v102, v103
    v_cvt_pk_bf16_f32 v27, v110, v111
    v_cvt_pk_bf16_f32 v35, -v110, -v111
    v_xor_b32 v20, v8, v16
    v_xor_b32 v21, v8, v17
    v_xor_b32 v22, v8, v18
    v_xor_b32 v23, v8, v19
    v_xor_b32 v28, v8, v24
    v_xor_b32 v29, v8, v25
    v_xor_b32 v30, v8, v26
    v_xor_b32 v31, v8, v27
    v_xor_b32 v36, v8, v32
    v_xor_b32 v37, v8, v33
    v_xor_b32 v38, v8, v34
    v_xor_b32 v39, v8, v35
    v_cvt_pk_bf16_f32 v40, v112, v113
    v_cvt_pk_bf16_f32 v48, v116, v117
    v_cvt_pk_bf16_f32 v56, -v116, -v117
    v_cvt_pk_bf16_f32 v41, v114, v115
    v_cvt_pk_bf16_f32 v49, v118, v119
    v_cvt_pk_bf16_f32 v57, -v118, -v119
    v_xor_b32 v42, v8, v40
    v_xor_b32 v43, v8, v41
    v_xor_b32 v44, 0x80000000, v40
    v_xor_b32 v45, 0x80000000, v41
    v_xor_b32 v46, 0x80000000, v42
    v_xor_b32 v47, 0x80000000, v43
    v_xor_b32 v50, v8, v48
    v_xor_b32 v51, v8, v49
    v_xor_b32 v52, 0x80000000, v48
    v_xor_b32 v53, 0x80000000, v49
    v_xor_b32 v54, 0x80000000, v50
    v_xor_b32 v55, 0x80000000, v51
    v_xor_b32 v58, v8, v56
    v_xor_b32 v59, v8, v57
    v_xor_b32 v60, 0x80000000, v56
    v_xor_b32 v61, 0x80000000, v57
    v_xor_b32 v62, 0x80000000, v58
    v_xor_b32 v63, 0x80000000, v59
    v_lshrrev_b32 v8, 2, v6
    v_and_b32 v9, 3, v6
    v_lshl_add_u32 v8, v5, 3, v8
    v_mul_u32_u24 v11, 72, v8
    v_lshl_add_u32 v11, v9, 4, v11
    v_add_u32 v11, s65, v11
    v_add_u32 v11, 32768, v11
    v_lshlrev_b32 v8, 6, v8
    v_add_u32 v8, s65, v8
    v_lshl_add_u32 v10, v9, 3, v8
    v_and_b32 v9, 1, v5
    v_lshl_add_u32 v10, v9, 5, v10
    v_xor_b32 v14, 32, v10
    v_lshlrev_b32 v12, 6, v4
    v_lshl_add_u32 v13, v5, 4, v12
    v_mul_u32_u24 v12, 72, v4
    v_lshl_add_u32 v12, v5, 3, v12
    v_add_u32 v12, s65, v12
    v_add_u32 v12, 32768, v12
    s_add_u32 s71, s64, 0
    s_mul_i32 s71, s71, 8448
    s_add_u32 s72, s71, 4224
    buffer_load_dwordx2 v[224:225], v3, s[60:63], s71 offen offset:0
    buffer_load_dwordx2 v[226:227], v3, s[60:63], s71 offen offset:32
    buffer_load_dwordx2 v[228:229], v3, s[60:63], s72 offen offset:0
    buffer_load_dwordx2 v[230:231], v3, s[60:63], s72 offen offset:32
    s_add_u32 s71, s64, 64
    s_mul_i32 s71, s71, 8448
    s_add_u32 s72, s71, 4224
    buffer_load_dwordx2 v[240:241], v3, s[60:63], s71 offen offset:0
    buffer_load_dwordx2 v[242:243], v3, s[60:63], s71 offen offset:32
    buffer_load_dwordx2 v[244:245], v3, s[60:63], s72 offen offset:0
    buffer_load_dwordx2 v[246:247], v3, s[60:63], s72 offen offset:32
    s_waitcnt vmcnt(8)
    s_barrier
    ds_read_b64_tr_b16 v[80:81], v10 offset:0
    ds_read_b64_tr_b16 v[82:83], v10 offset:256
    ds_read_b64_tr_b16 v[84:85], v10 offset:2048
    ds_read_b64_tr_b16 v[86:87], v10 offset:2304
    ds_read_b64_tr_b16 v[88:89], v14 offset:0
    ds_read_b64_tr_b16 v[90:91], v14 offset:256
    ds_read_b64_tr_b16 v[92:93], v14 offset:2048
    ds_read_b64_tr_b16 v[94:95], v14 offset:2304
    ds_read_b64_tr_b16 v[96:97], v10 offset:4096
    ds_read_b64_tr_b16 v[98:99], v10 offset:4352
    ds_read_b64_tr_b16 v[100:101], v10 offset:6144
    ds_read_b64_tr_b16 v[102:103], v10 offset:6400
    ds_read_b64_tr_b16 v[104:105], v14 offset:4096
    ds_read_b64_tr_b16 v[106:107], v14 offset:4352
    ds_read_b64_tr_b16 v[108:109], v14 offset:6144
    ds_read_b64_tr_b16 v[110:111], v14 offset:6400
    ds_read_b64_tr_b16 v[152:153], v10 offset:8192
    ds_read_b64_tr_b16 v[154:155], v10 offset:8448
    ds_read_b64_tr_b16 v[156:157], v10 offset:10240
    ds_read_b64_tr_b16 v[158:159], v10 offset:10496
    ds_read_b64_tr_b16 v[160:161], v14 offset:8192
    ds_read_b64_tr_b16 v[162:163], v14 offset:8448
    ds_read_b64_tr_b16 v[164:165], v14 offset:10240
    ds_read_b64_tr_b16 v[166:167], v14 offset:10496
    ds_read_b64_tr_b16 v[168:169], v10 offset:12288
    ds_read_b64_tr_b16 v[170:171], v10 offset:12544
    ds_read_b64_tr_b16 v[172:173], v10 offset:14336
    ds_read_b64_tr_b16 v[174:175], v10 offset:14592
    ds_read_b64_tr_b16 v[176:177], v14 offset:12288
    ds_read_b64_tr_b16 v[178:179], v14 offset:12544
    ds_read_b64_tr_b16 v[180:181], v14 offset:14336
    ds_read_b64_tr_b16 v[182:183], v14 offset:14592
    s_waitcnt lgkmcnt(0)
    v_mfma_f32_16x16x32_bf16 v[112:115], v[80:83], v[16:19], 0
    v_mfma_f32_16x16x32_bf16 v[120:123], v[96:99], v[16:19], 0
    v_mfma_f32_16x16x32_bf16 v[112:115], v[96:99], v[24:27], v[112:115]
    v_mfma_f32_16x16x32_bf16 v[120:123], v[80:83], v[32:35], v[120:123]
    v_mfma_f32_16x16x32_bf16 v[112:115], v[84:87], v[20:23], v[112:115]
    v_mfma_f32_16x16x32_bf16 v[120:123], v[100:103], v[20:23], v[120:123]
    v_mfma_f32_16x16x32_bf16 v[112:115], v[100:103], v[28:31], v[112:115]
    v_mfma_f32_16x16x32_bf16 v[120:123], v[84:87], v[36:39], v[120:123]
    v_mfma_f32_16x16x32_bf16 v[116:119], v[88:91], v[16:19], 0
    v_mfma_f32_16x16x32_bf16 v[124:127], v[104:107], v[16:19], 0
    v_mfma_f32_16x16x32_bf16 v[116:119], v[104:107], v[24:27], v[116:119]
    v_mfma_f32_16x16x32_bf16 v[124:127], v[88:91], v[32:35], v[124:127]
    v_mfma_f32_16x16x32_bf16 v[116:119], v[92:95], v[20:23], v[116:119]
    v_mfma_f32_16x16x32_bf16 v[124:127], v[108:111], v[20:23], v[124:127]
    v_mfma_f32_16x16x32_bf16 v[116:119], v[108:111], v[28:31], v[116:119]
    v_mfma_f32_16x16x32_bf16 v[124:127], v[92:95], v[36:39], v[124:127]
    s_add_u32 s71, s64, 128
    s_mul_i32 s71, s71, 8448
    s_add_u32 s66, s67, 16384
    s_mov_b32 m0, s66
    s_add_u32 s72, s71, 4224
    buffer_load_dwordx4 v2, s[52:55], s71 offen lds
    s_add_u32 s66, s66, 4096
    s_mov_b32 m0, s66
    s_nop 0
    buffer_load_dwordx4 v2, s[52:55], s72 offen lds
    v_mul_f32 v128, v112, v64
    v_mul_f32 v136, v120, v64
    v_mfma_f32_16x16x32_bf16 v[184:187], v[152:155], v[16:19], 0
    v_fmac_f32 v128, v120, v72
    v_fma_f32 v136, -v112, v72, v136
    v_mfma_f32_16x16x32_bf16 v[192:195], v[168:171], v[16:19], 0
    v_mul_f32 v129, v113, v65
    v_mul_f32 v137, v121, v65
    v_mfma_f32_16x16x32_bf16 v[184:187], v[168:171], v[24:27], v[184:187]
    v_fmac_f32 v129, v121, v73
    v_fma_f32 v137, -v113, v73, v137
    v_mfma_f32_16x16x32_bf16 v[192:195], v[152:155], v[32:35], v[192:195]
    v_mul_f32 v130, v114, v66
    v_mul_f32 v138, v122, v66
    v_mfma_f32_16x16x32_bf16 v[184:187], v[156:159], v[20:23], v[184:187]
    v_fmac_f32 v130, v122, v74
    v_fma_f32 v138, -v114, v74, v138
    v_mfma_f32_16x16x32_bf16 v[192:195], v[172:175], v[20:23], v[192:195]
    v_mul_f32 v131, v115, v67
    v_mul_f32 v139, v123, v67
    v_mfma_f32_16x16x32_bf16 v[184:187], v[172:175], v[28:31], v[184:187]
    v_fmac_f32 v131, v123, v75
    v_fma_f32 v139, -v115, v75, v139
    v_mfma_f32_16x16x32_bf16 v[192:195], v[156:159], v[36:39], v[192:195]
    v_mul_f32 v132, v116, v68
    v_mul_f32 v140, v124, v68
    v_mfma_f32_16x16x32_bf16 v[188:191], v[160:163], v[16:19], 0
    v_fmac_f32 v132, v124, v76
    v_fma_f32 v140, -v116, v76, v140
    v_mfma_f32_16x16x32_bf16 v[196:199], v[176:179], v[16:19], 0
    v_mul_f32 v133, v117, v69
    v_mul_f32 v141, v125, v69
    v_mfma_f32_16x16x32_bf16 v[188:191], v[176:179], v[24:27], v[188:191]
    v_fmac_f32 v133, v125, v77
    v_fma_f32 v141, -v117, v77, v141
    v_mfma_f32_16x16x32_bf16 v[196:199], v[160:163], v[32:35], v[196:199]
    v_mul_f32 v134, v118, v70
    v_mul_f32 v142, v126, v70
    v_mfma_f32_16x16x32_bf16 v[188:191], v[164:167], v[20:23], v[188:191]
    v_fmac_f32 v134, v126, v78
    v_fma_f32 v142, -v118, v78, v142
    v_mfma_f32_16x16x32_bf16 v[196:199], v[180:183], v[20:23], v[196:199]
    v_mul_f32 v135, v119, v71
    v_mul_f32 v143, v127, v71
    v_mfma_f32_16x16x32_bf16 v[188:191], v[180:183], v[28:31], v[188:191]
    v_fmac_f32 v135, v127, v79
    v_fma_f32 v143, -v119, v79, v143
    v_mfma_f32_16x16x32_bf16 v[196:199], v[164:167], v[36:39], v[196:199]
    v_cvt_pk_bf16_f32 v144, v128, v129
    v_cvt_pk_bf16_f32 v148, v136, v137
    v_cvt_pk_bf16_f32 v145, v130, v131
    v_cvt_pk_bf16_f32 v149, v138, v139
    v_cvt_pk_bf16_f32 v146, v132, v133
    v_cvt_pk_bf16_f32 v150, v140, v141
    v_cvt_pk_bf16_f32 v147, v134, v135
    v_cvt_pk_bf16_f32 v151, v142, v143
    s_add_u32 s71, s64, 192
    s_mul_i32 s71, s71, 8448
    s_add_u32 s66, s67, 24576
    s_mov_b32 m0, s66
    s_add_u32 s72, s71, 4224
    buffer_load_dwordx4 v2, s[52:55], s71 offen lds
    s_add_u32 s66, s66, 4096
    s_mov_b32 m0, s66
    s_nop 0
    buffer_load_dwordx4 v2, s[52:55], s72 offen lds
    v_mul_f32 v200, v184, v64
    v_mul_f32 v208, v192, v64
    v_mfma_f32_16x16x32_bf16 v[112:115], v[40:43], v[144:147], 0
    v_fmac_f32 v200, v192, v72
    v_fma_f32 v208, -v184, v72, v208
    v_mfma_f32_16x16x32_bf16 v[120:123], v[40:43], v[148:151], 0
    v_mul_f32 v201, v185, v65
    v_mul_f32 v209, v193, v65
    v_mfma_f32_16x16x32_bf16 v[112:115], v[48:51], v[148:151], v[112:115]
    v_fmac_f32 v201, v193, v73
    v_fma_f32 v209, -v185, v73, v209
    v_mfma_f32_16x16x32_bf16 v[120:123], v[56:59], v[144:147], v[120:123]
    v_mul_f32 v202, v186, v66
    v_mul_f32 v210, v194, v66
    v_mfma_f32_16x16x32_bf16 v[116:119], v[44:47], v[144:147], 0
    v_fmac_f32 v202, v194, v74
    v_fma_f32 v210, -v186, v74, v210
    v_mfma_f32_16x16x32_bf16 v[124:127], v[44:47], v[148:151], 0
    v_mul_f32 v203, v187, v67
    v_mul_f32 v211, v195, v67
    v_mfma_f32_16x16x32_bf16 v[116:119], v[52:55], v[148:151], v[116:119]
    v_fmac_f32 v203, v195, v75
    v_fma_f32 v211, -v187, v75, v211
    v_mfma_f32_16x16x32_bf16 v[124:127], v[60:63], v[144:147], v[124:127]
    v_mul_f32 v204, v188, v68
    v_mul_f32 v212, v196, v68
    v_fmac_f32 v204, v196, v76
    v_fma_f32 v212, -v188, v76, v212
    v_mul_f32 v205, v189, v69
    v_mul_f32 v213, v197, v69
    v_fmac_f32 v205, v197, v77
    v_fma_f32 v213, -v189, v77, v213
    v_mul_f32 v206, v190, v70
    v_mul_f32 v214, v198, v70
    v_fmac_f32 v206, v198, v78
    v_fma_f32 v214, -v190, v78, v214
    v_mul_f32 v207, v191, v71
    v_mul_f32 v215, v199, v71
    v_fmac_f32 v207, v199, v79
    v_fma_f32 v215, -v191, v79, v215
    v_cvt_pk_bf16_f32 v216, v200, v201
    v_cvt_pk_bf16_f32 v220, v208, v209
    v_cvt_pk_bf16_f32 v217, v202, v203
    v_cvt_pk_bf16_f32 v221, v210, v211
    v_cvt_pk_bf16_f32 v218, v204, v205
    v_cvt_pk_bf16_f32 v222, v212, v213
    v_cvt_pk_bf16_f32 v219, v206, v207
    v_cvt_pk_bf16_f32 v223, v214, v215
    s_waitcnt vmcnt(4)
    v_lshlrev_b32 v80, 16, v224
    v_and_b32 v81, 0xffff0000, v224
    v_mfma_f32_16x16x32_bf16 v[184:187], v[40:43], v[216:219], 0
    v_lshlrev_b32 v82, 16, v225
    v_and_b32 v83, 0xffff0000, v225
    v_mfma_f32_16x16x32_bf16 v[192:195], v[40:43], v[220:223], 0
    v_lshlrev_b32 v84, 16, v226
    v_and_b32 v85, 0xffff0000, v226
    v_mfma_f32_16x16x32_bf16 v[184:187], v[48:51], v[220:223], v[184:187]
    v_lshlrev_b32 v86, 16, v227
    v_and_b32 v87, 0xffff0000, v227
    v_mfma_f32_16x16x32_bf16 v[192:195], v[56:59], v[216:219], v[192:195]
    v_lshlrev_b32 v88, 16, v228
    v_and_b32 v89, 0xffff0000, v228
    v_mfma_f32_16x16x32_bf16 v[188:191], v[44:47], v[216:219], 0
    v_lshlrev_b32 v90, 16, v229
    v_and_b32 v91, 0xffff0000, v229
    v_mfma_f32_16x16x32_bf16 v[196:199], v[44:47], v[220:223], 0
    v_lshlrev_b32 v92, 16, v230
    v_and_b32 v93, 0xffff0000, v230
    v_mfma_f32_16x16x32_bf16 v[188:191], v[52:55], v[220:223], v[188:191]
    v_lshlrev_b32 v94, 16, v231
    v_and_b32 v95, 0xffff0000, v231
    v_mfma_f32_16x16x32_bf16 v[196:199], v[60:63], v[216:219], v[196:199]
    v_pk_mul_f32 v[128:129], v[112:113], v[80:81]
    v_pk_mul_f32 v[136:137], v[112:113], v[88:89]
    v_pk_fma_f32 v[128:129], v[120:121], v[88:89], v[128:129] neg_lo:[1,0,0] neg_hi:[1,0,0]
    v_pk_fma_f32 v[136:137], v[120:121], v[80:81], v[136:137]
    v_pk_mul_f32 v[130:131], v[114:115], v[82:83]
    v_pk_mul_f32 v[138:139], v[114:115], v[90:91]
    v_pk_fma_f32 v[130:131], v[122:123], v[90:91], v[130:131] neg_lo:[1,0,0] neg_hi:[1,0,0]
    v_pk_fma_f32 v[138:139], v[122:123], v[82:83], v[138:139]
    v_pk_mul_f32 v[132:133], v[116:117], v[84:85]
    v_pk_mul_f32 v[140:141], v[116:117], v[92:93]
    v_pk_fma_f32 v[132:133], v[124:125], v[92:93], v[132:133] neg_lo:[1,0,0] neg_hi:[1,0,0]
    v_pk_fma_f32 v[140:141], v[124:125], v[84:85], v[140:141]
    v_pk_mul_f32 v[134:135], v[118:119], v[86:87]
    v_pk_mul_f32 v[142:143], v[118:119], v[94:95]
    v_pk_fma_f32 v[134:135], v[126:127], v[94:95], v[134:135] neg_lo:[1,0,0] neg_hi:[1,0,0]
    v_pk_fma_f32 v[142:143], v[126:127], v[86:87], v[142:143]
    v_cvt_pk_bf16_f32 v144, v128, v129
    v_cvt_pk_bf16_f32 v148, v136, v137
    v_cvt_pk_bf16_f32 v145, v130, v131
    v_cvt_pk_bf16_f32 v149, v138, v139
    v_cvt_pk_bf16_f32 v146, v132, v133
    v_cvt_pk_bf16_f32 v150, v140, v141
    v_cvt_pk_bf16_f32 v147, v134, v135
    v_cvt_pk_bf16_f32 v151, v142, v143
    v_lshlrev_b32 v152, 16, v240
    v_and_b32 v153, 0xffff0000, v240
    v_mfma_f32_16x16x32_bf16 v[112:115], v[40:43], v[144:147], 0
    v_lshlrev_b32 v154, 16, v241
    v_and_b32 v155, 0xffff0000, v241
    v_mfma_f32_16x16x32_bf16 v[120:123], v[40:43], v[148:151], 0
    v_lshlrev_b32 v156, 16, v242
    v_and_b32 v157, 0xffff0000, v242
    v_mfma_f32_16x16x32_bf16 v[112:115], v[56:59], v[148:151], v[112:115]
    v_lshlrev_b32 v158, 16, v243
    v_and_b32 v159, 0xffff0000, v243
    v_mfma_f32_16x16x32_bf16 v[120:123], v[48:51], v[144:147], v[120:123]
    v_lshlrev_b32 v160, 16, v244
    v_and_b32 v161, 0xffff0000, v244
    v_mfma_f32_16x16x32_bf16 v[116:119], v[44:47], v[144:147], 0
    v_lshlrev_b32 v162, 16, v245
    v_and_b32 v163, 0xffff0000, v245
    v_mfma_f32_16x16x32_bf16 v[124:127], v[44:47], v[148:151], 0
    v_lshlrev_b32 v164, 16, v246
    v_and_b32 v165, 0xffff0000, v246
    v_mfma_f32_16x16x32_bf16 v[116:119], v[60:63], v[148:151], v[116:119]
    v_lshlrev_b32 v166, 16, v247
    v_and_b32 v167, 0xffff0000, v247
    v_mfma_f32_16x16x32_bf16 v[124:127], v[52:55], v[144:147], v[124:127]
    v_pk_mul_f32 v[200:201], v[184:185], v[152:153]
    v_pk_mul_f32 v[208:209], v[184:185], v[160:161]
    v_pk_fma_f32 v[200:201], v[192:193], v[160:161], v[200:201] neg_lo:[1,0,0] neg_hi:[1,0,0]
    v_pk_fma_f32 v[208:209], v[192:193], v[152:153], v[208:209]
    v_pk_mul_f32 v[202:203], v[186:187], v[154:155]
    v_pk_mul_f32 v[210:211], v[186:187], v[162:163]
    v_pk_fma_f32 v[202:203], v[194:195], v[162:163], v[202:203] neg_lo:[1,0,0] neg_hi:[1,0,0]
    v_pk_fma_f32 v[210:211], v[194:195], v[154:155], v[210:211]
    v_pk_mul_f32 v[204:205], v[188:189], v[156:157]
    v_pk_mul_f32 v[212:213], v[188:189], v[164:165]
    v_pk_fma_f32 v[204:205], v[196:197], v[164:165], v[204:205] neg_lo:[1,0,0] neg_hi:[1,0,0]
    v_pk_fma_f32 v[212:213], v[196:197], v[156:157], v[212:213]
    v_pk_mul_f32 v[206:207], v[190:191], v[158:159]
    v_pk_mul_f32 v[214:215], v[190:191], v[166:167]
    v_pk_fma_f32 v[206:207], v[198:199], v[166:167], v[206:207] neg_lo:[1,0,0] neg_hi:[1,0,0]
    v_pk_fma_f32 v[214:215], v[198:199], v[158:159], v[214:215]
    v_cvt_pk_bf16_f32 v216, v200, v201
    v_cvt_pk_bf16_f32 v220, v208, v209
    v_cvt_pk_bf16_f32 v217, v202, v203
    v_cvt_pk_bf16_f32 v221, v210, v211
    v_cvt_pk_bf16_f32 v218, v204, v205
    v_cvt_pk_bf16_f32 v222, v212, v213
    v_cvt_pk_bf16_f32 v219, v206, v207
    v_cvt_pk_bf16_f32 v223, v214, v215
    s_add_u32 s71, s64, 128
    s_mul_i32 s71, s71, 8448
    s_add_u32 s72, s71, 4224
    buffer_load_dwordx2 v[224:225], v3, s[60:63], s71 offen offset:0
    buffer_load_dwordx2 v[226:227], v3, s[60:63], s71 offen offset:32
    buffer_load_dwordx2 v[228:229], v3, s[60:63], s72 offen offset:0
    buffer_load_dwordx2 v[230:231], v3, s[60:63], s72 offen offset:32
    s_add_u32 s71, s64, 192
    s_mul_i32 s71, s71, 8448
    s_add_u32 s72, s71, 4224
    buffer_load_dwordx2 v[240:241], v3, s[60:63], s71 offen offset:0
    buffer_load_dwordx2 v[242:243], v3, s[60:63], s71 offen offset:32
    buffer_load_dwordx2 v[244:245], v3, s[60:63], s72 offen offset:0
    buffer_load_dwordx2 v[246:247], v3, s[60:63], s72 offen offset:32
    v_mul_f32 v128, v112, v64
    v_mul_f32 v136, v120, v64
    v_mfma_f32_16x16x32_bf16 v[184:187], v[40:43], v[216:219], 0
    v_fma_f32 v128, -v120, v72, v128
    v_fmac_f32 v136, v112, v72
    v_mfma_f32_16x16x32_bf16 v[192:195], v[40:43], v[220:223], 0
    v_mul_f32 v129, v113, v65
    v_mul_f32 v137, v121, v65
    v_mfma_f32_16x16x32_bf16 v[184:187], v[56:59], v[220:223], v[184:187]
    v_fma_f32 v129, -v121, v73, v129
    v_fmac_f32 v137, v113, v73
    v_mfma_f32_16x16x32_bf16 v[192:195], v[48:51], v[216:219], v[192:195]
    v_mul_f32 v130, v114, v66
    v_mul_f32 v138, v122, v66
    v_mfma_f32_16x16x32_bf16 v[188:191], v[44:47], v[216:219], 0
    v_fma_f32 v130, -v122, v74, v130
    v_fmac_f32 v138, v114, v74
    v_mfma_f32_16x16x32_bf16 v[196:199], v[44:47], v[220:223], 0
    v_mul_f32 v131, v115, v67
    v_mul_f32 v139, v123, v67
    v_mfma_f32_16x16x32_bf16 v[188:191], v[60:63], v[220:223], v[188:191]
    v_fma_f32 v131, -v123, v75, v131
    v_fmac_f32 v139, v115, v75
    v_mfma_f32_16x16x32_bf16 v[196:199], v[52:55], v[216:219], v[196:199]
    v_mul_f32 v132, v116, v68
    v_mul_f32 v140, v124, v68
    v_fma_f32 v132, -v124, v76, v132
    v_fmac_f32 v140, v116, v76
    v_mul_f32 v133, v117, v69
    v_mul_f32 v141, v125, v69
    v_fma_f32 v133, -v125, v77, v133
    v_fmac_f32 v141, v117, v77
    v_mul_f32 v134, v118, v70
    v_mul_f32 v142, v126, v70
    v_fma_f32 v134, -v126, v78, v134
    v_fmac_f32 v142, v118, v78
    v_mul_f32 v135, v119, v71
    v_mul_f32 v143, v127, v71
    v_fma_f32 v135, -v127, v79, v135
    v_fmac_f32 v143, v119, v79
    v_cvt_pk_bf16_f32 v144, v128, v129
    v_cvt_pk_bf16_f32 v148, v136, v137
    v_cvt_pk_bf16_f32 v145, v130, v131
    v_cvt_pk_bf16_f32 v149, v138, v139
    v_cvt_pk_bf16_f32 v146, v132, v133
    v_cvt_pk_bf16_f32 v150, v140, v141
    v_cvt_pk_bf16_f32 v147, v134, v135
    v_cvt_pk_bf16_f32 v151, v142, v143
    ds_write_b64 v12, v[144:145] offset:0
    ds_write_b64 v12, v[148:149] offset:4608
    ds_write_b64 v12, v[146:147] offset:32
    ds_write_b64 v12, v[150:151] offset:4640
    v_pk_mul_f32 v[200:201], v[184:185], v[64:65]
    v_pk_mul_f32 v[208:209], v[192:193], v[64:65]
    v_pk_fma_f32 v[200:201], v[192:193], v[72:73], v[200:201] neg_lo:[1,0,0] neg_hi:[1,0,0]
    v_pk_fma_f32 v[208:209], v[184:185], v[72:73], v[208:209]
    v_pk_mul_f32 v[202:203], v[186:187], v[66:67]
    v_pk_mul_f32 v[210:211], v[194:195], v[66:67]
    v_pk_fma_f32 v[202:203], v[194:195], v[74:75], v[202:203] neg_lo:[1,0,0] neg_hi:[1,0,0]
    v_pk_fma_f32 v[210:211], v[186:187], v[74:75], v[210:211]
    v_pk_mul_f32 v[204:205], v[188:189], v[68:69]
    v_pk_mul_f32 v[212:213], v[196:197], v[68:69]
    v_pk_fma_f32 v[204:205], v[196:197], v[76:77], v[204:205] neg_lo:[1,0,0] neg_hi:[1,0,0]
    v_pk_fma_f32 v[212:213], v[188:189], v[76:77], v[212:213]
    v_pk_mul_f32 v[206:207], v[190:191], v[70:71]
    v_pk_mul_f32 v[214:215], v[198:199], v[70:71]
    v_pk_fma_f32 v[206:207], v[198:199], v[78:79], v[206:207] neg_lo:[1,0,0] neg_hi:[1,0,0]
    v_pk_fma_f32 v[214:215], v[190:191], v[78:79], v[214:215]
    v_cvt_pk_bf16_f32 v216, v200, v201
    v_cvt_pk_bf16_f32 v220, v208, v209
    v_cvt_pk_bf16_f32 v217, v202, v203
    v_cvt_pk_bf16_f32 v221, v210, v211
    v_cvt_pk_bf16_f32 v218, v204, v205
    v_cvt_pk_bf16_f32 v222, v212, v213
    v_cvt_pk_bf16_f32 v219, v206, v207
    v_cvt_pk_bf16_f32 v223, v214, v215
    ds_write_b64 v12, v[216:217] offset:9216
    ds_write_b64 v12, v[220:221] offset:13824
    ds_write_b64 v12, v[218:219] offset:9248
    ds_write_b64 v12, v[222:223] offset:13856
    s_waitcnt vmcnt(8)
    s_barrier
    ds_read_b64_tr_b16 v[80:81], v10 offset:16384
    ds_read_b64_tr_b16 v[82:83], v10 offset:16640
    ds_read_b64_tr_b16 v[84:85], v10 offset:18432
    ds_read_b64_tr_b16 v[86:87], v10 offset:18688
    ds_read_b64_tr_b16 v[88:89], v14 offset:16384
    ds_read_b64_tr_b16 v[90:91], v14 offset:16640
    ds_read_b64_tr_b16 v[92:93], v14 offset:18432
    ds_read_b64_tr_b16 v[94:95], v14 offset:18688
    ds_read_b64_tr_b16 v[96:97], v10 offset:20480
    ds_read_b64_tr_b16 v[98:99], v10 offset:20736
    ds_read_b64_tr_b16 v[100:101], v10 offset:22528
    ds_read_b64_tr_b16 v[102:103], v10 offset:22784
    ds_read_b64_tr_b16 v[104:105], v14 offset:20480
    ds_read_b64_tr_b16 v[106:107], v14 offset:20736
    ds_read_b64_tr_b16 v[108:109], v14 offset:22528
    ds_read_b64_tr_b16 v[110:111], v14 offset:22784
    ds_read_b64_tr_b16 v[152:153], v10 offset:24576
    ds_read_b64_tr_b16 v[154:155], v10 offset:24832
    ds_read_b64_tr_b16 v[156:157], v10 offset:26624
    ds_read_b64_tr_b16 v[158:159], v10 offset:26880
    ds_read_b64_tr_b16 v[160:161], v14 offset:24576
    ds_read_b64_tr_b16 v[162:163], v14 offset:24832
    ds_read_b64_tr_b16 v[164:165], v14 offset:26624
    ds_read_b64_tr_b16 v[166:167], v14 offset:26880
    ds_read_b64_tr_b16 v[168:169], v10 offset:28672
    ds_read_b64_tr_b16 v[170:171], v10 offset:28928
    ds_read_b64_tr_b16 v[172:173], v10 offset:30720
    ds_read_b64_tr_b16 v[174:175], v10 offset:30976
    ds_read_b64_tr_b16 v[176:177], v14 offset:28672
    ds_read_b64_tr_b16 v[178:179], v14 offset:28928
    ds_read_b64_tr_b16 v[180:181], v14 offset:30720
    ds_read_b64_tr_b16 v[182:183], v14 offset:30976
    s_waitcnt lgkmcnt(0)
    v_mfma_f32_16x16x32_bf16 v[112:115], v[80:83], v[16:19], 0
    v_mfma_f32_16x16x32_bf16 v[120:123], v[96:99], v[16:19], 0
    v_mfma_f32_16x16x32_bf16 v[112:115], v[96:99], v[24:27], v[112:115]
    v_mfma_f32_16x16x32_bf16 v[120:123], v[80:83], v[32:35], v[120:123]
    v_mfma_f32_16x16x32_bf16 v[112:115], v[84:87], v[20:23], v[112:115]
    v_mfma_f32_16x16x32_bf16 v[120:123], v[100:103], v[20:23], v[120:123]
    v_mfma_f32_16x16x32_bf16 v[112:115], v[100:103], v[28:31], v[112:115]
    v_mfma_f32_16x16x32_bf16 v[120:123], v[84:87], v[36:39], v[120:123]
    v_mfma_f32_16x16x32_bf16 v[116:119], v[88:91], v[16:19], 0
    v_mfma_f32_16x16x32_bf16 v[124:127], v[104:107], v[16:19], 0
    v_mfma_f32_16x16x32_bf16 v[116:119], v[104:107], v[24:27], v[116:119]
    v_mfma_f32_16x16x32_bf16 v[124:127], v[88:91], v[32:35], v[124:127]
    v_mfma_f32_16x16x32_bf16 v[116:119], v[92:95], v[20:23], v[116:119]
    v_mfma_f32_16x16x32_bf16 v[124:127], v[108:111], v[20:23], v[124:127]
    v_mfma_f32_16x16x32_bf16 v[116:119], v[108:111], v[28:31], v[116:119]
    v_mfma_f32_16x16x32_bf16 v[124:127], v[92:95], v[36:39], v[124:127]
    s_nop 3
    v_mul_f32 v128, v112, v64
    v_mul_f32 v136, v120, v64
    v_mfma_f32_16x16x32_bf16 v[184:187], v[152:155], v[16:19], 0
    v_fmac_f32 v128, v120, v72
    v_fma_f32 v136, -v112, v72, v136
    v_mfma_f32_16x16x32_bf16 v[192:195], v[168:171], v[16:19], 0
    v_mul_f32 v129, v113, v65
    v_mul_f32 v137, v121, v65
    v_mfma_f32_16x16x32_bf16 v[184:187], v[168:171], v[24:27], v[184:187]
    v_fmac_f32 v129, v121, v73
    v_fma_f32 v137, -v113, v73, v137
    v_mfma_f32_16x16x32_bf16 v[192:195], v[152:155], v[32:35], v[192:195]
    v_mul_f32 v130, v114, v66
    v_mul_f32 v138, v122, v66
    v_mfma_f32_16x16x32_bf16 v[184:187], v[156:159], v[20:23], v[184:187]
    v_fmac_f32 v130, v122, v74
    v_fma_f32 v138, -v114, v74, v138
    v_mfma_f32_16x16x32_bf16 v[192:195], v[172:175], v[20:23], v[192:195]
    v_mul_f32 v131, v115, v67
    v_mul_f32 v139, v123, v67
    v_mfma_f32_16x16x32_bf16 v[184:187], v[172:175], v[28:31], v[184:187]
    v_fmac_f32 v131, v123, v75
    v_fma_f32 v139, -v115, v75, v139
    v_mfma_f32_16x16x32_bf16 v[192:195], v[156:159], v[36:39], v[192:195]
    v_mul_f32 v132, v116, v68
    v_mul_f32 v140, v124, v68
    v_mfma_f32_16x16x32_bf16 v[188:191], v[160:163], v[16:19], 0
    v_fmac_f32 v132, v124, v76
    v_fma_f32 v140, -v116, v76, v140
    v_mfma_f32_16x16x32_bf16 v[196:199], v[176:179], v[16:19], 0
    v_mul_f32 v133, v117, v69
    v_mul_f32 v141, v125, v69
    v_mfma_f32_16x16x32_bf16 v[188:191], v[176:179], v[24:27], v[188:191]
    v_fmac_f32 v133, v125, v77
    v_fma_f32 v141, -v117, v77, v141
    v_mfma_f32_16x16x32_bf16 v[196:199], v[160:163], v[32:35], v[196:199]
    v_mul_f32 v134, v118, v70
    v_mul_f32 v142, v126, v70
    v_mfma_f32_16x16x32_bf16 v[188:191], v[164:167], v[20:23], v[188:191]
    v_fmac_f32 v134, v126, v78
    v_fma_f32 v142, -v118, v78, v142
    v_mfma_f32_16x16x32_bf16 v[196:199], v[180:183], v[20:23], v[196:199]
    v_mul_f32 v135, v119, v71
    v_mul_f32 v143, v127, v71
    v_mfma_f32_16x16x32_bf16 v[188:191], v[180:183], v[28:31], v[188:191]
    v_fmac_f32 v135, v127, v79
    v_fma_f32 v143, -v119, v79, v143
    v_mfma_f32_16x16x32_bf16 v[196:199], v[164:167], v[36:39], v[196:199]
    v_cvt_pk_bf16_f32 v144, v128, v129
    v_cvt_pk_bf16_f32 v148, v136, v137
    v_cvt_pk_bf16_f32 v145, v130, v131
    v_cvt_pk_bf16_f32 v149, v138, v139
    v_cvt_pk_bf16_f32 v146, v132, v133
    v_cvt_pk_bf16_f32 v150, v140, v141
    v_cvt_pk_bf16_f32 v147, v134, v135
    v_cvt_pk_bf16_f32 v151, v142, v143
    v_mul_f32 v200, v184, v64
    v_mul_f32 v208, v192, v64
    v_mfma_f32_16x16x32_bf16 v[112:115], v[40:43], v[144:147], 0
    v_fmac_f32 v200, v192, v72
    v_fma_f32 v208, -v184, v72, v208
    v_mfma_f32_16x16x32_bf16 v[120:123], v[40:43], v[148:151], 0
    v_mul_f32 v201, v185, v65
    v_mul_f32 v209, v193, v65
    v_mfma_f32_16x16x32_bf16 v[112:115], v[48:51], v[148:151], v[112:115]
    v_fmac_f32 v201, v193, v73
    v_fma_f32 v209, -v185, v73, v209
    v_mfma_f32_16x16x32_bf16 v[120:123], v[56:59], v[144:147], v[120:123]
    v_mul_f32 v202, v186, v66
    v_mul_f32 v210, v194, v66
    v_mfma_f32_16x16x32_bf16 v[116:119], v[44:47], v[144:147], 0
    v_fmac_f32 v202, v194, v74
    v_fma_f32 v210, -v186, v74, v210
    v_mfma_f32_16x16x32_bf16 v[124:127], v[44:47], v[148:151], 0
    v_mul_f32 v203, v187, v67
    v_mul_f32 v211, v195, v67
    v_mfma_f32_16x16x32_bf16 v[116:119], v[52:55], v[148:151], v[116:119]
    v_fmac_f32 v203, v195, v75
    v_fma_f32 v211, -v187, v75, v211
    v_mfma_f32_16x16x32_bf16 v[124:127], v[60:63], v[144:147], v[124:127]
    v_mul_f32 v204, v188, v68
    v_mul_f32 v212, v196, v68
    v_fmac_f32 v204, v196, v76
    v_fma_f32 v212, -v188, v76, v212
    v_mul_f32 v205, v189, v69
    v_mul_f32 v213, v197, v69
    v_fmac_f32 v205, v197, v77
    v_fma_f32 v213, -v189, v77, v213
    v_mul_f32 v206, v190, v70
    v_mul_f32 v214, v198, v70
    v_fmac_f32 v206, v198, v78
    v_fma_f32 v214, -v190, v78, v214
    v_mul_f32 v207, v191, v71
    v_mul_f32 v215, v199, v71
    v_fmac_f32 v207, v199, v79
    v_fma_f32 v215, -v191, v79, v215
    v_cvt_pk_bf16_f32 v216, v200, v201
    v_cvt_pk_bf16_f32 v220, v208, v209
    v_cvt_pk_bf16_f32 v217, v202, v203
    v_cvt_pk_bf16_f32 v221, v210, v211
    v_cvt_pk_bf16_f32 v218, v204, v205
    v_cvt_pk_bf16_f32 v222, v212, v213
    v_cvt_pk_bf16_f32 v219, v206, v207
    v_cvt_pk_bf16_f32 v223, v214, v215
    s_waitcnt vmcnt(0)
    v_lshlrev_b32 v80, 16, v224
    v_and_b32 v81, 0xffff0000, v224
    v_mfma_f32_16x16x32_bf16 v[184:187], v[40:43], v[216:219], 0
    v_lshlrev_b32 v82, 16, v225
    v_and_b32 v83, 0xffff0000, v225
    v_mfma_f32_16x16x32_bf16 v[192:195], v[40:43], v[220:223], 0
    v_lshlrev_b32 v84, 16, v226
    v_and_b32 v85, 0xffff0000, v226
    v_mfma_f32_16x16x32_bf16 v[184:187], v[48:51], v[220:223], v[184:187]
    v_lshlrev_b32 v86, 16, v227
    v_and_b32 v87, 0xffff0000, v227
    v_mfma_f32_16x16x32_bf16 v[192:195], v[56:59], v[216:219], v[192:195]
    v_lshlrev_b32 v88, 16, v228
    v_and_b32 v89, 0xffff0000, v228
    v_mfma_f32_16x16x32_bf16 v[188:191], v[44:47], v[216:219], 0
    v_lshlrev_b32 v90, 16, v229
    v_and_b32 v91, 0xffff0000, v229
    v_mfma_f32_16x16x32_bf16 v[196:199], v[44:47], v[220:223], 0
    v_lshlrev_b32 v92, 16, v230
    v_and_b32 v93, 0xffff0000, v230
    v_mfma_f32_16x16x32_bf16 v[188:191], v[52:55], v[220:223], v[188:191]
    v_lshlrev_b32 v94, 16, v231
    v_and_b32 v95, 0xffff0000, v231
    v_mfma_f32_16x16x32_bf16 v[196:199], v[60:63], v[216:219], v[196:199]
    v_pk_mul_f32 v[128:129], v[112:113], v[80:81]
    v_pk_mul_f32 v[136:137], v[112:113], v[88:89]
    v_pk_fma_f32 v[128:129], v[120:121], v[88:89], v[128:129] neg_lo:[1,0,0] neg_hi:[1,0,0]
    v_pk_fma_f32 v[136:137], v[120:121], v[80:81], v[136:137]
    v_pk_mul_f32 v[130:131], v[114:115], v[82:83]
    v_pk_mul_f32 v[138:139], v[114:115], v[90:91]
    v_pk_fma_f32 v[130:131], v[122:123], v[90:91], v[130:131] neg_lo:[1,0,0] neg_hi:[1,0,0]
    v_pk_fma_f32 v[138:139], v[122:123], v[82:83], v[138:139]
    v_pk_mul_f32 v[132:133], v[116:117], v[84:85]
    v_pk_mul_f32 v[140:141], v[116:117], v[92:93]
    v_pk_fma_f32 v[132:133], v[124:125], v[92:93], v[132:133] neg_lo:[1,0,0] neg_hi:[1,0,0]
    v_pk_fma_f32 v[140:141], v[124:125], v[84:85], v[140:141]
    v_pk_mul_f32 v[134:135], v[118:119], v[86:87]
    v_pk_mul_f32 v[142:143], v[118:119], v[94:95]
    v_pk_fma_f32 v[134:135], v[126:127], v[94:95], v[134:135] neg_lo:[1,0,0] neg_hi:[1,0,0]
    v_pk_fma_f32 v[142:143], v[126:127], v[86:87], v[142:143]
    v_cvt_pk_bf16_f32 v144, v128, v129
    v_cvt_pk_bf16_f32 v148, v136, v137
    v_cvt_pk_bf16_f32 v145, v130, v131
    v_cvt_pk_bf16_f32 v149, v138, v139
    v_cvt_pk_bf16_f32 v146, v132, v133
    v_cvt_pk_bf16_f32 v150, v140, v141
    v_cvt_pk_bf16_f32 v147, v134, v135
    v_cvt_pk_bf16_f32 v151, v142, v143
    v_lshlrev_b32 v152, 16, v240
    v_and_b32 v153, 0xffff0000, v240
    v_mfma_f32_16x16x32_bf16 v[112:115], v[40:43], v[144:147], 0
    v_lshlrev_b32 v154, 16, v241
    v_and_b32 v155, 0xffff0000, v241
    v_mfma_f32_16x16x32_bf16 v[120:123], v[40:43], v[148:151], 0
    v_lshlrev_b32 v156, 16, v242
    v_and_b32 v157, 0xffff0000, v242
    v_mfma_f32_16x16x32_bf16 v[112:115], v[56:59], v[148:151], v[112:115]
    v_lshlrev_b32 v158, 16, v243
    v_and_b32 v159, 0xffff0000, v243
    v_mfma_f32_16x16x32_bf16 v[120:123], v[48:51], v[144:147], v[120:123]
    v_lshlrev_b32 v160, 16, v244
    v_and_b32 v161, 0xffff0000, v244
    v_mfma_f32_16x16x32_bf16 v[116:119], v[44:47], v[144:147], 0
    v_lshlrev_b32 v162, 16, v245
    v_and_b32 v163, 0xffff0000, v245
    v_mfma_f32_16x16x32_bf16 v[124:127], v[44:47], v[148:151], 0
    v_lshlrev_b32 v164, 16, v246
    v_and_b32 v165, 0xffff0000, v246
    v_mfma_f32_16x16x32_bf16 v[116:119], v[60:63], v[148:151], v[116:119]
    v_lshlrev_b32 v166, 16, v247
    v_and_b32 v167, 0xffff0000, v247
    v_mfma_f32_16x16x32_bf16 v[124:127], v[52:55], v[144:147], v[124:127]
    v_pk_mul_f32 v[200:201], v[184:185], v[152:153]
    v_pk_mul_f32 v[208:209], v[184:185], v[160:161]
    v_pk_fma_f32 v[200:201], v[192:193], v[160:161], v[200:201] neg_lo:[1,0,0] neg_hi:[1,0,0]
    v_pk_fma_f32 v[208:209], v[192:193], v[152:153], v[208:209]
    v_pk_mul_f32 v[202:203], v[186:187], v[154:155]
    v_pk_mul_f32 v[210:211], v[186:187], v[162:163]
    v_pk_fma_f32 v[202:203], v[194:195], v[162:163], v[202:203] neg_lo:[1,0,0] neg_hi:[1,0,0]
    v_pk_fma_f32 v[210:211], v[194:195], v[154:155], v[210:211]
    v_pk_mul_f32 v[204:205], v[188:189], v[156:157]
    v_pk_mul_f32 v[212:213], v[188:189], v[164:165]
    v_pk_fma_f32 v[204:205], v[196:197], v[164:165], v[204:205] neg_lo:[1,0,0] neg_hi:[1,0,0]
    v_pk_fma_f32 v[212:213], v[196:197], v[156:157], v[212:213]
    v_pk_mul_f32 v[206:207], v[190:191], v[158:159]
    v_pk_mul_f32 v[214:215], v[190:191], v[166:167]
    v_pk_fma_f32 v[206:207], v[198:199], v[166:167], v[206:207] neg_lo:[1,0,0] neg_hi:[1,0,0]
    v_pk_fma_f32 v[214:215], v[198:199], v[158:159], v[214:215]
    v_cvt_pk_bf16_f32 v216, v200, v201
    v_cvt_pk_bf16_f32 v220, v208, v209
    v_cvt_pk_bf16_f32 v217, v202, v203
    v_cvt_pk_bf16_f32 v221, v210, v211
    v_cvt_pk_bf16_f32 v218, v204, v205
    v_cvt_pk_bf16_f32 v222, v212, v213
    v_cvt_pk_bf16_f32 v219, v206, v207
    v_cvt_pk_bf16_f32 v223, v214, v215
    v_mul_f32 v128, v112, v64
    v_mul_f32 v136, v120, v64
    v_mfma_f32_16x16x32_bf16 v[184:187], v[40:43], v[216:219], 0
    v_fma_f32 v128, -v120, v72, v128
    v_fmac_f32 v136, v112, v72
    v_mfma_f32_16x16x32_bf16 v[192:195], v[40:43], v[220:223], 0
    v_mul_f32 v129, v113, v65
    v_mul_f32 v137, v121, v65
    v_mfma_f32_16x16x32_bf16 v[184:187], v[56:59], v[220:223], v[184:187]
    v_fma_f32 v129, -v121, v73, v129
    v_fmac_f32 v137, v113, v73
    v_mfma_f32_16x16x32_bf16 v[192:195], v[48:51], v[216:219], v[192:195]
    v_mul_f32 v130, v114, v66
    v_mul_f32 v138, v122, v66
    v_mfma_f32_16x16x32_bf16 v[188:191], v[44:47], v[216:219], 0
    v_fma_f32 v130, -v122, v74, v130
    v_fmac_f32 v138, v114, v74
    v_mfma_f32_16x16x32_bf16 v[196:199], v[44:47], v[220:223], 0
    v_mul_f32 v131, v115, v67
    v_mul_f32 v139, v123, v67
    v_mfma_f32_16x16x32_bf16 v[188:191], v[60:63], v[220:223], v[188:191]
    v_fma_f32 v131, -v123, v75, v131
    v_fmac_f32 v139, v115, v75
    v_mfma_f32_16x16x32_bf16 v[196:199], v[52:55], v[216:219], v[196:199]
    v_mul_f32 v132, v116, v68
    v_mul_f32 v140, v124, v68
    v_fma_f32 v132, -v124, v76, v132
    v_fmac_f32 v140, v116, v76
    v_mul_f32 v133, v117, v69
    v_mul_f32 v141, v125, v69
    v_fma_f32 v133, -v125, v77, v133
    v_fmac_f32 v141, v117, v77
    v_mul_f32 v134, v118, v70
    v_mul_f32 v142, v126, v70
    v_fma_f32 v134, -v126, v78, v134
    v_fmac_f32 v142, v118, v78
    v_mul_f32 v135, v119, v71
    v_mul_f32 v143, v127, v71
    v_fma_f32 v135, -v127, v79, v135
    v_fmac_f32 v143, v119, v79
    v_cvt_pk_bf16_f32 v144, v128, v129
    v_cvt_pk_bf16_f32 v148, v136, v137
    v_cvt_pk_bf16_f32 v145, v130, v131
    v_cvt_pk_bf16_f32 v149, v138, v139
    v_cvt_pk_bf16_f32 v146, v132, v133
    v_cvt_pk_bf16_f32 v150, v140, v141
    v_cvt_pk_bf16_f32 v147, v134, v135
    v_cvt_pk_bf16_f32 v151, v142, v143
    ds_write_b64 v12, v[144:145] offset:18432
    ds_write_b64 v12, v[148:149] offset:23040
    ds_write_b64 v12, v[146:147] offset:18464
    ds_write_b64 v12, v[150:151] offset:23072
    v_pk_mul_f32 v[200:201], v[184:185], v[64:65]
    v_pk_mul_f32 v[208:209], v[192:193], v[64:65]
    v_pk_fma_f32 v[200:201], v[192:193], v[72:73], v[200:201] neg_lo:[1,0,0] neg_hi:[1,0,0]
    v_pk_fma_f32 v[208:209], v[184:185], v[72:73], v[208:209]
    v_pk_mul_f32 v[202:203], v[186:187], v[66:67]
    v_pk_mul_f32 v[210:211], v[194:195], v[66:67]
    v_pk_fma_f32 v[202:203], v[194:195], v[74:75], v[202:203] neg_lo:[1,0,0] neg_hi:[1,0,0]
    v_pk_fma_f32 v[210:211], v[186:187], v[74:75], v[210:211]
    v_pk_mul_f32 v[204:205], v[188:189], v[68:69]
    v_pk_mul_f32 v[212:213], v[196:197], v[68:69]
    v_pk_fma_f32 v[204:205], v[196:197], v[76:77], v[204:205] neg_lo:[1,0,0] neg_hi:[1,0,0]
    v_pk_fma_f32 v[212:213], v[188:189], v[76:77], v[212:213]
    v_pk_mul_f32 v[206:207], v[190:191], v[70:71]
    v_pk_mul_f32 v[214:215], v[198:199], v[70:71]
    v_pk_fma_f32 v[206:207], v[198:199], v[78:79], v[206:207] neg_lo:[1,0,0] neg_hi:[1,0,0]
    v_pk_fma_f32 v[214:215], v[190:191], v[78:79], v[214:215]
    v_cvt_pk_bf16_f32 v216, v200, v201
    v_cvt_pk_bf16_f32 v220, v208, v209
    v_cvt_pk_bf16_f32 v217, v202, v203
    v_cvt_pk_bf16_f32 v221, v210, v211
    v_cvt_pk_bf16_f32 v218, v204, v205
    v_cvt_pk_bf16_f32 v222, v212, v213
    v_cvt_pk_bf16_f32 v219, v206, v207
    v_cvt_pk_bf16_f32 v223, v214, v215
    ds_write_b64 v12, v[216:217] offset:27648
    ds_write_b64 v12, v[220:221] offset:32256
    ds_write_b64 v12, v[218:219] offset:27680
    ds_write_b64 v12, v[222:223] offset:32288
    s_waitcnt lgkmcnt(0)
    s_barrier
    ds_read_b64_tr_b16 v[80:81], v11 offset:0
    ds_read_b64_tr_b16 v[82:83], v11 offset:288
    ds_read_b64_tr_b16 v[84:85], v11 offset:2304
    ds_read_b64_tr_b16 v[86:87], v11 offset:2592
    ds_read_b64_tr_b16 v[88:89], v11 offset:8
    ds_read_b64_tr_b16 v[90:91], v11 offset:296
    ds_read_b64_tr_b16 v[92:93], v11 offset:2312
    ds_read_b64_tr_b16 v[94:95], v11 offset:2600
    ds_read_b64_tr_b16 v[96:97], v11 offset:4608
    ds_read_b64_tr_b16 v[98:99], v11 offset:4896
    ds_read_b64_tr_b16 v[100:101], v11 offset:6912
    ds_read_b64_tr_b16 v[102:103], v11 offset:7200
    ds_read_b64_tr_b16 v[104:105], v11 offset:4616
    ds_read_b64_tr_b16 v[106:107], v11 offset:4904
    ds_read_b64_tr_b16 v[108:109], v11 offset:6920
    ds_read_b64_tr_b16 v[110:111], v11 offset:7208
    ds_read_b64_tr_b16 v[152:153], v11 offset:9216
    ds_read_b64_tr_b16 v[154:155], v11 offset:9504
    ds_read_b64_tr_b16 v[156:157], v11 offset:11520
    ds_read_b64_tr_b16 v[158:159], v11 offset:11808
    ds_read_b64_tr_b16 v[160:161], v11 offset:9224
    ds_read_b64_tr_b16 v[162:163], v11 offset:9512
    ds_read_b64_tr_b16 v[164:165], v11 offset:11528
    ds_read_b64_tr_b16 v[166:167], v11 offset:11816
    ds_read_b64_tr_b16 v[168:169], v11 offset:13824
    ds_read_b64_tr_b16 v[170:171], v11 offset:14112
    ds_read_b64_tr_b16 v[172:173], v11 offset:16128
    ds_read_b64_tr_b16 v[174:175], v11 offset:16416
    ds_read_b64_tr_b16 v[176:177], v11 offset:13832
    ds_read_b64_tr_b16 v[178:179], v11 offset:14120
    ds_read_b64_tr_b16 v[180:181], v11 offset:16136
    ds_read_b64_tr_b16 v[182:183], v11 offset:16424
    s_waitcnt lgkmcnt(0)
    v_mfma_f32_16x16x32_bf16 v[112:115], v[80:83], v[16:19], 0
    v_mfma_f32_16x16x32_bf16 v[120:123], v[96:99], v[16:19], 0
    v_mfma_f32_16x16x32_bf16 v[112:115], v[96:99], v[32:35], v[112:115]
    v_mfma_f32_16x16x32_bf16 v[120:123], v[80:83], v[24:27], v[120:123]
    v_mfma_f32_16x16x32_bf16 v[112:115], v[84:87], v[20:23], v[112:115]
    v_mfma_f32_16x16x32_bf16 v[120:123], v[100:103], v[20:23], v[120:123]
    v_mfma_f32_16x16x32_bf16 v[112:115], v[100:103], v[36:39], v[112:115]
    v_mfma_f32_16x16x32_bf16 v[120:123], v[84:87], v[28:31], v[120:123]
    v_mfma_f32_16x16x32_bf16 v[116:119], v[88:91], v[16:19], 0
    v_mfma_f32_16x16x32_bf16 v[124:127], v[104:107], v[16:19], 0
    v_mfma_f32_16x16x32_bf16 v[116:119], v[104:107], v[32:35], v[116:119]
    v_mfma_f32_16x16x32_bf16 v[124:127], v[88:91], v[24:27], v[124:127]
    v_mfma_f32_16x16x32_bf16 v[116:119], v[92:95], v[20:23], v[116:119]
    v_mfma_f32_16x16x32_bf16 v[124:127], v[108:111], v[20:23], v[124:127]
    v_mfma_f32_16x16x32_bf16 v[116:119], v[108:111], v[36:39], v[116:119]
    v_mfma_f32_16x16x32_bf16 v[124:127], v[92:95], v[28:31], v[124:127]
    s_nop 3
    s_add_u32 s66, s64, 0
    s_mul_i32 s71, s66, 8448
    v_mfma_f32_16x16x32_bf16 v[184:187], v[152:155], v[16:19], 0
    s_add_u32 s72, s71, 4224
    v_mfma_f32_16x16x32_bf16 v[192:195], v[168:171], v[16:19], 0
    s_cmp_eq_u32 s66, 0
    v_mfma_f32_16x16x32_bf16 v[184:187], v[168:171], v[32:35], v[184:187]
    s_cselect_b32 s72, 0x7ff00000, s72
    v_mfma_f32_16x16x32_bf16 v[192:195], v[152:155], v[24:27], v[192:195]
    v_cvt_pk_bf16_f32 v144, v112, v113
    v_mfma_f32_16x16x32_bf16 v[184:187], v[156:159], v[20:23], v[184:187]
    v_cvt_pk_bf16_f32 v148, v120, v121
    v_mfma_f32_16x16x32_bf16 v[192:195], v[172:175], v[20:23], v[192:195]
    v_cvt_pk_bf16_f32 v145, v114, v115
    v_mfma_f32_16x16x32_bf16 v[184:187], v[172:175], v[36:39], v[184:187]
    v_cvt_pk_bf16_f32 v149, v122, v123
    v_mfma_f32_16x16x32_bf16 v[192:195], v[156:159], v[28:31], v[192:195]
    v_cvt_pk_bf16_f32 v146, v116, v117
    v_mfma_f32_16x16x32_bf16 v[188:191], v[160:163], v[16:19], 0
    v_cvt_pk_bf16_f32 v150, v124, v125
    v_mfma_f32_16x16x32_bf16 v[196:199], v[176:179], v[16:19], 0
    v_cvt_pk_bf16_f32 v147, v118, v119
    v_mfma_f32_16x16x32_bf16 v[188:191], v[176:179], v[32:35], v[188:191]
    v_cvt_pk_bf16_f32 v151, v126, v127
    v_mfma_f32_16x16x32_bf16 v[196:199], v[160:163], v[24:27], v[196:199]
    buffer_store_dwordx4 v[144:147], v13, s[56:59], s71 offen
    v_mfma_f32_16x16x32_bf16 v[188:191], v[164:167], v[20:23], v[188:191]
    buffer_store_dwordx4 v[148:151], v13, s[56:59], s72 offen
    v_mfma_f32_16x16x32_bf16 v[196:199], v[180:183], v[20:23], v[196:199]
    v_mfma_f32_16x16x32_bf16 v[188:191], v[180:183], v[36:39], v[188:191]
    v_mfma_f32_16x16x32_bf16 v[196:199], v[164:167], v[28:31], v[196:199]
    ds_read_b64_tr_b16 v[80:81], v11 offset:18432
    ds_read_b64_tr_b16 v[82:83], v11 offset:18720
    ds_read_b64_tr_b16 v[84:85], v11 offset:20736
    ds_read_b64_tr_b16 v[86:87], v11 offset:21024
    ds_read_b64_tr_b16 v[88:89], v11 offset:18440
    ds_read_b64_tr_b16 v[90:91], v11 offset:18728
    ds_read_b64_tr_b16 v[92:93], v11 offset:20744
    ds_read_b64_tr_b16 v[94:95], v11 offset:21032
    ds_read_b64_tr_b16 v[96:97], v11 offset:23040
    ds_read_b64_tr_b16 v[98:99], v11 offset:23328
    ds_read_b64_tr_b16 v[100:101], v11 offset:25344
    ds_read_b64_tr_b16 v[102:103], v11 offset:25632
    ds_read_b64_tr_b16 v[104:105], v11 offset:23048
    ds_read_b64_tr_b16 v[106:107], v11 offset:23336
    ds_read_b64_tr_b16 v[108:109], v11 offset:25352
    ds_read_b64_tr_b16 v[110:111], v11 offset:25640
    s_nop 7
    s_add_u32 s66, s64, 64
    s_mul_i32 s71, s66, 8448
    s_add_u32 s72, s71, 4224
    v_cvt_pk_bf16_f32 v216, v184, v185
    v_cvt_pk_bf16_f32 v220, v192, v193
    v_cvt_pk_bf16_f32 v217, v186, v187
    v_cvt_pk_bf16_f32 v221, v194, v195
    v_cvt_pk_bf16_f32 v218, v188, v189
    v_cvt_pk_bf16_f32 v222, v196, v197
    v_cvt_pk_bf16_f32 v219, v190, v191
    v_cvt_pk_bf16_f32 v223, v198, v199
    buffer_store_dwordx4 v[216:219], v13, s[56:59], s71 offen
    buffer_store_dwordx4 v[220:223], v13, s[56:59], s72 offen
    ds_read_b64_tr_b16 v[152:153], v11 offset:27648
    ds_read_b64_tr_b16 v[154:155], v11 offset:27936
    ds_read_b64_tr_b16 v[156:157], v11 offset:29952
    ds_read_b64_tr_b16 v[158:159], v11 offset:30240
    ds_read_b64_tr_b16 v[160:161], v11 offset:27656
    ds_read_b64_tr_b16 v[162:163], v11 offset:27944
    ds_read_b64_tr_b16 v[164:165], v11 offset:29960
    ds_read_b64_tr_b16 v[166:167], v11 offset:30248
    ds_read_b64_tr_b16 v[168:169], v11 offset:32256
    ds_read_b64_tr_b16 v[170:171], v11 offset:32544
    ds_read_b64_tr_b16 v[172:173], v11 offset:34560
    ds_read_b64_tr_b16 v[174:175], v11 offset:34848
    ds_read_b64_tr_b16 v[176:177], v11 offset:32264
    ds_read_b64_tr_b16 v[178:179], v11 offset:32552
    ds_read_b64_tr_b16 v[180:181], v11 offset:34568
    ds_read_b64_tr_b16 v[182:183], v11 offset:34856
    s_nop 0
    s_waitcnt lgkmcnt(0)
    v_mfma_f32_16x16x32_bf16 v[112:115], v[80:83], v[16:19], 0
    v_mfma_f32_16x16x32_bf16 v[120:123], v[96:99], v[16:19], 0
    v_mfma_f32_16x16x32_bf16 v[112:115], v[96:99], v[32:35], v[112:115]
    v_mfma_f32_16x16x32_bf16 v[120:123], v[80:83], v[24:27], v[120:123]
    v_mfma_f32_16x16x32_bf16 v[112:115], v[84:87], v[20:23], v[112:115]
    v_mfma_f32_16x16x32_bf16 v[120:123], v[100:103], v[20:23], v[120:123]
    v_mfma_f32_16x16x32_bf16 v[112:115], v[100:103], v[36:39], v[112:115]
    v_mfma_f32_16x16x32_bf16 v[120:123], v[84:87], v[28:31], v[120:123]
    v_mfma_f32_16x16x32_bf16 v[116:119], v[88:91], v[16:19], 0
    v_mfma_f32_16x16x32_bf16 v[124:127], v[104:107], v[16:19], 0
    v_mfma_f32_16x16x32_bf16 v[116:119], v[104:107], v[32:35], v[116:119]
    v_mfma_f32_16x16x32_bf16 v[124:127], v[88:91], v[24:27], v[124:127]
    v_mfma_f32_16x16x32_bf16 v[116:119], v[92:95], v[20:23], v[116:119]
    v_mfma_f32_16x16x32_bf16 v[124:127], v[108:111], v[20:23], v[124:127]
    v_mfma_f32_16x16x32_bf16 v[116:119], v[108:111], v[36:39], v[116:119]
    v_mfma_f32_16x16x32_bf16 v[124:127], v[92:95], v[28:31], v[124:127]
    s_nop 3
    s_add_u32 s66, s64, 128
    s_mul_i32 s71, s66, 8448
    v_mfma_f32_16x16x32_bf16 v[184:187], v[152:155], v[16:19], 0
    s_add_u32 s72, s71, 4224
    v_mfma_f32_16x16x32_bf16 v[192:195], v[168:171], v[16:19], 0
    v_cvt_pk_bf16_f32 v144, v112, v113
    v_mfma_f32_16x16x32_bf16 v[184:187], v[168:171], v[32:35], v[184:187]
    v_cvt_pk_bf16_f32 v148, v120, v121
    v_mfma_f32_16x16x32_bf16 v[192:195], v[152:155], v[24:27], v[192:195]
    v_cvt_pk_bf16_f32 v145, v114, v115
    v_mfma_f32_16x16x32_bf16 v[184:187], v[156:159], v[20:23], v[184:187]
    v_cvt_pk_bf16_f32 v149, v122, v123
    v_mfma_f32_16x16x32_bf16 v[192:195], v[172:175], v[20:23], v[192:195]
    v_cvt_pk_bf16_f32 v146, v116, v117
    v_mfma_f32_16x16x32_bf16 v[184:187], v[172:175], v[36:39], v[184:187]
    v_cvt_pk_bf16_f32 v150, v124, v125
    v_mfma_f32_16x16x32_bf16 v[192:195], v[156:159], v[28:31], v[192:195]
    v_cvt_pk_bf16_f32 v147, v118, v119
    v_mfma_f32_16x16x32_bf16 v[188:191], v[160:163], v[16:19], 0
    v_cvt_pk_bf16_f32 v151, v126, v127
    v_mfma_f32_16x16x32_bf16 v[196:199], v[176:179], v[16:19], 0
    buffer_store_dwordx4 v[144:147], v13, s[56:59], s71 offen
    v_mfma_f32_16x16x32_bf16 v[188:191], v[176:179], v[32:35], v[188:191]
    buffer_store_dwordx4 v[148:151], v13, s[56:59], s72 offen
    v_mfma_f32_16x16x32_bf16 v[196:199], v[160:163], v[24:27], v[196:199]
    v_mfma_f32_16x16x32_bf16 v[188:191], v[164:167], v[20:23], v[188:191]
    v_mfma_f32_16x16x32_bf16 v[196:199], v[180:183], v[20:23], v[196:199]
    v_mfma_f32_16x16x32_bf16 v[188:191], v[180:183], v[36:39], v[188:191]
    v_mfma_f32_16x16x32_bf16 v[196:199], v[164:167], v[28:31], v[196:199]
    s_nop 7
    s_add_u32 s66, s64, 192
    s_mul_i32 s71, s66, 8448
    s_add_u32 s72, s71, 4224
    s_cmp_eq_u32 s66, 224
    s_cselect_b32 s71, 4224, s71
    s_cselect_b32 s72, 0x7ff00000, s72
    v_cvt_pk_bf16_f32 v216, v184, v185
    v_cvt_pk_bf16_f32 v220, v192, v193
    v_cvt_pk_bf16_f32 v217, v186, v187
    v_cvt_pk_bf16_f32 v221, v194, v195
    v_cvt_pk_bf16_f32 v218, v188, v189
    v_cvt_pk_bf16_f32 v222, v196, v197
    v_cvt_pk_bf16_f32 v219, v190, v191
    v_cvt_pk_bf16_f32 v223, v198, v199
    buffer_store_dwordx4 v[216:219], v13, s[56:59], s71 offen
    buffer_store_dwordx4 v[220:223], v13, s[56:59], s72 offen
    s_nop 0
    s_endpgm
L_k1_gemm:
    s_and_b32 s4, s2, 7
    s_lshr_b32 s5, s2, 3
    s_sub_u32 s5, s5, 4
    s_lshr_b32 s6, s4, 2
    s_and_b32 s7, s4, 3
    s_lshl_b32 s6, s6, 2
    s_and_b32 s8, s5, 3
    s_add_u32 s4, s6, s8
    s_mul_i32 s7, s7, 7
    s_lshr_b32 s5, s5, 2
    s_add_u32 s5, s7, s5
    v_and_b32 v3, 31, v2
    v_lshl_add_u32 v3, v1, 5, v3
    v_lshrrev_b32 v4, 5, v2
    s_mul_i32 s6, s4, 229376
    v_lshrrev_b32 v5, 3, v2
    v_lshl_add_u32 v5, v1, 5, v5
    v_mul_u32_u24 v5, 896, v5
    v_and_b32 v7, 7, v2
    v_lshrrev_b32 v8, 4, v2
    v_xor_b32 v8, v7, v8
    v_lshl_add_u32 v20, v8, 4, v5
    v_xor_b32 v8, 4, v8
    v_lshl_add_u32 v21, v8, 4, v5
    v_add_u32 v21, 7168, v21
    v_lshrrev_b32 v6, 3, v2
    v_lshl_add_u32 v6, v1, 3, v6
    v_mul_u32_u24 v6, 3584, v6
    v_bfe_u32 v8, v2, 4, 1
    v_lshlrev_b32 v8, 2, v8
    v_xor_b32 v7, v7, v8
    v_lshl_add_u32 v6, v7, 4, v6
    s_lshl_b32 s7, s5, 7
    s_lshl_b32 s8, s3, 10
    s_lshl_b32 s11, s3, 12
    s_waitcnt lgkmcnt(0)
    s_mov_b32 s36, s34
    s_mov_b32 s37, s35
    s_mov_b32 s38, 0x1c0000
    s_mov_b32 s39, 0x00020000
    s_mov_b32 s40, s24
    s_mov_b32 s41, s25
    s_mov_b32 s42, 0x188000
    s_mov_b32 s43, 0x00020000
    s_mov_b32 s44, s26
    s_mov_b32 s45, s27
    s_mov_b32 s46, 0x188000
    s_mov_b32 s47, 0x00020000
    s_add_u32 s48, s34, 0x800000
    s_addc_u32 s49, s35, 0
    s_mov_b32 s50, 0x740000
    s_mov_b32 s51, 0x00020000
    s_add_u32 s9, s7, 0
    s_add_u32 s10, s8, 32768
    s_mov_b32 m0, s10
    s_add_u32 s10, s10, 8192
    buffer_load_dwordx4 v6, s[40:43], s9 offen lds
    s_mov_b32 m0, s10
    s_add_u32 s14, s6, 0
    buffer_load_dwordx4 v6, s[44:47], s9 offen lds
    s_add_u32 s10, s11, 0
    s_mov_b32 m0, s10
    s_nop 0
    buffer_load_dwordx4 v20, s[36:39], s14 offen lds
    s_add_u32 s10, s11, 1024
    s_mov_b32 m0, s10
    s_nop 0
    buffer_load_dwordx4 v21, s[36:39], s14 offen lds
    s_add_u32 s10, s11, 2048
    s_mov_b32 m0, s10
    s_add_u32 s14, s14, 14336
    buffer_load_dwordx4 v20, s[36:39], s14 offen lds
    s_add_u32 s10, s11, 3072
    s_mov_b32 m0, s10
    s_nop 0
    buffer_load_dwordx4 v21, s[36:39], s14 offen lds
    v_lshrrev_b32 v8, 4, v2
    v_and_b32 v9, 15, v2
    v_lshrrev_b32 v10, 2, v9
    v_and_b32 v11, 3, v9
    v_lshrrev_b32 v12, 1, v8
    v_lshl_add_u32 v12, v12, 3, v10
    v_lshlrev_b32 v12, 7, v12
    v_and_b32 v13, 1, v11
    v_lshlrev_b32 v13, 1, v13
    v_and_b32 v14, 1, v8
    v_add_u32 v13, v13, v14
    v_lshrrev_b32 v14, 1, v10
    v_lshl_add_u32 v13, v14, 2, v13
    v_lshl_add_u32 v12, v13, 4, v12
    v_lshrrev_b32 v14, 1, v11
    v_lshl_add_u32 v16, v14, 3, v12
    v_xor_b32 v17, 64, v16
    v_add_u32 v24, 32768, v16
    v_add_u32 v25, 32768, v17
    v_add_u32 v26, 81920, v16
    v_add_u32 v27, 81920, v17
    v_add_u32 v28, 131072, v16
    v_add_u32 v29, 131072, v17
    v_bfe_u32 v9, v3, 1, 3
    v_add_u32 v10, 0, v4
    v_xor_b32 v10, v10, v9
    v_lshlrev_b32 v10, 4, v10
    v_lshl_add_u32 v10, v3, 7, v10
    v_add_u32 v96, 0, v10
    v_add_u32 v100, 49152, v10
    v_add_u32 v104, 98304, v10
    v_add_u32 v10, 2, v4
    v_xor_b32 v10, v10, v9
    v_lshlrev_b32 v10, 4, v10
    v_lshl_add_u32 v10, v3, 7, v10
    v_add_u32 v97, 0, v10
    v_add_u32 v101, 49152, v10
    v_add_u32 v105, 98304, v10
    v_add_u32 v10, 4, v4
    v_xor_b32 v10, v10, v9
    v_lshlrev_b32 v10, 4, v10
    v_lshl_add_u32 v10, v3, 7, v10
    v_add_u32 v98, 0, v10
    v_add_u32 v102, 49152, v10
    v_add_u32 v106, 98304, v10
    v_add_u32 v10, 6, v4
    v_xor_b32 v10, v10, v9
    v_lshlrev_b32 v10, 4, v10
    v_lshl_add_u32 v10, v3, 7, v10
    v_add_u32 v99, 0, v10
    v_add_u32 v103, 49152, v10
    v_add_u32 v107, 98304, v10
    v_mov_b32 v112, 0
    v_mov_b32 v113, 0
    v_mov_b32 v114, 0
    v_mov_b32 v115, 0
    v_mov_b32 v116, 0
    v_mov_b32 v117, 0
    v_mov_b32 v118, 0
    v_mov_b32 v119, 0
    v_mov_b32 v120, 0
    v_mov_b32 v121, 0
    v_mov_b32 v122, 0
    v_mov_b32 v123, 0
    v_mov_b32 v124, 0
    v_mov_b32 v125, 0
    v_mov_b32 v126, 0
    v_mov_b32 v127, 0
    v_mov_b32 v128, 0
    v_mov_b32 v129, 0
    v_mov_b32 v130, 0
    v_mov_b32 v131, 0
    v_mov_b32 v132, 0
    v_mov_b32 v133, 0
    v_mov_b32 v134, 0
    v_mov_b32 v135, 0
    v_mov_b32 v136, 0
    v_mov_b32 v137, 0
    v_mov_b32 v138, 0
    v_mov_b32 v139, 0
    v_mov_b32 v140, 0
    v_mov_b32 v141, 0
    v_mov_b32 v142, 0
    v_mov_b32 v143, 0
    v_mov_b32 v144, 0
    v_mov_b32 v145, 0
    v_mov_b32 v146, 0
    v_mov_b32 v147, 0
    v_mov_b32 v148, 0
    v_mov_b32 v149, 0
    v_mov_b32 v150, 0
    v_mov_b32 v151, 0
    v_mov_b32 v152, 0
    v_mov_b32 v153, 0
    v_mov_b32 v154, 0
    v_mov_b32 v155, 0
    v_mov_b32 v156, 0
    v_mov_b32 v157, 0
    v_mov_b32 v158, 0
    v_mov_b32 v159, 0
    v_mov_b32 v160, 0
    v_mov_b32 v161, 0
    v_mov_b32 v162, 0
    v_mov_b32 v163, 0
    v_mov_b32 v164, 0
    v_mov_b32 v165, 0
    v_mov_b32 v166, 0
    v_mov_b32 v167, 0
    v_mov_b32 v168, 0
    v_mov_b32 v169, 0
    v_mov_b32 v170, 0
    v_mov_b32 v171, 0
    v_mov_b32 v172, 0
    v_mov_b32 v173, 0
    v_mov_b32 v174, 0
    v_mov_b32 v175, 0
    s_add_u32 s9, s7, 229376
    s_add_u32 s10, s8, 81920
    s_mov_b32 m0, s10
    s_add_u32 s10, s10, 8192
    buffer_load_dwordx4 v6, s[40:43], s9 offen lds
    s_mov_b32 m0, s10
    s_add_u32 s14, s6, 128
    buffer_load_dwordx4 v6, s[44:47], s9 offen lds
    s_add_u32 s10, s11, 49152
    s_mov_b32 m0, s10
    s_nop 0
    buffer_load_dwordx4 v20, s[36:39], s14 offen lds
    s_add_u32 s10, s11, 50176
    s_mov_b32 m0, s10
    s_nop 0
    buffer_load_dwordx4 v21, s[36:39], s14 offen lds
    s_add_u32 s10, s11, 51200
    s_mov_b32 m0, s10
    s_add_u32 s14, s14, 14336
    buffer_load_dwordx4 v20, s[36:39], s14 offen lds
    s_add_u32 s10, s11, 52224
    s_mov_b32 m0, s10
    s_nop 0
    buffer_load_dwordx4 v21, s[36:39], s14 offen lds
    s_waitcnt vmcnt(6)
    s_barrier
    ds_read_b128 v[48:51], v96
    ds_read_b64_tr_b16 v[32:33], v24 offset:0
    ds_read_b64_tr_b16 v[34:35], v24 offset:512
    ds_read_b64_tr_b16 v[36:37], v25 offset:0
    ds_read_b64_tr_b16 v[38:39], v25 offset:512
    ds_read_b64_tr_b16 v[40:41], v24 offset:8192
    ds_read_b64_tr_b16 v[42:43], v24 offset:8704
    ds_read_b64_tr_b16 v[44:45], v25 offset:8192
    ds_read_b64_tr_b16 v[46:47], v25 offset:8704
    ds_read_b128 v[68:71], v97
    ds_read_b64_tr_b16 v[52:53], v24 offset:2048
    ds_read_b64_tr_b16 v[54:55], v24 offset:2560
    ds_read_b64_tr_b16 v[56:57], v25 offset:2048
    ds_read_b64_tr_b16 v[58:59], v25 offset:2560
    ds_read_b64_tr_b16 v[60:61], v24 offset:10240
    ds_read_b64_tr_b16 v[62:63], v24 offset:10752
    ds_read_b64_tr_b16 v[64:65], v25 offset:10240
    ds_read_b64_tr_b16 v[66:67], v25 offset:10752
    s_waitcnt lgkmcnt(9)
    v_mfma_f32_32x32x16_bf16 v[112:127], v[32:35], v[48:51], v[112:127]
    s_add_u32 s9, s7, 458752
    s_add_u32 s10, s8, 131072
    s_mov_b32 m0, s10
    s_add_u32 s10, s10, 8192
    buffer_load_dwordx4 v6, s[40:43], s9 offen lds
    v_mfma_f32_32x32x16_bf16 v[128:143], v[36:39], v[48:51], v[128:143]
    v_mfma_f32_32x32x16_bf16 v[144:159], v[40:43], v[48:51], v[144:159]
    s_mov_b32 m0, s10
    s_add_u32 s14, s6, 256
    buffer_load_dwordx4 v6, s[44:47], s9 offen lds
    v_mfma_f32_32x32x16_bf16 v[160:175], v[44:47], v[48:51], v[160:175]
    ds_read_b128 v[48:51], v98
    ds_read_b64_tr_b16 v[32:33], v24 offset:4096
    ds_read_b64_tr_b16 v[34:35], v24 offset:4608
    ds_read_b64_tr_b16 v[36:37], v25 offset:4096
    ds_read_b64_tr_b16 v[38:39], v25 offset:4608
    ds_read_b64_tr_b16 v[40:41], v24 offset:12288
    ds_read_b64_tr_b16 v[42:43], v24 offset:12800
    ds_read_b64_tr_b16 v[44:45], v25 offset:12288
    ds_read_b64_tr_b16 v[46:47], v25 offset:12800
    s_waitcnt lgkmcnt(9)
    v_mfma_f32_32x32x16_bf16 v[112:127], v[52:55], v[68:71], v[112:127]
    s_add_u32 s10, s11, 98304
    s_mov_b32 m0, s10
    s_nop 0
    buffer_load_dwordx4 v20, s[36:39], s14 offen lds
    v_mfma_f32_32x32x16_bf16 v[128:143], v[56:59], v[68:71], v[128:143]
    v_mfma_f32_32x32x16_bf16 v[144:159], v[60:63], v[68:71], v[144:159]
    s_add_u32 s10, s11, 99328
    s_mov_b32 m0, s10
    s_nop 0
    buffer_load_dwordx4 v21, s[36:39], s14 offen lds
    v_mfma_f32_32x32x16_bf16 v[160:175], v[64:67], v[68:71], v[160:175]
    ds_read_b128 v[68:71], v99
    ds_read_b64_tr_b16 v[52:53], v24 offset:6144
    ds_read_b64_tr_b16 v[54:55], v24 offset:6656
    ds_read_b64_tr_b16 v[56:57], v25 offset:6144
    ds_read_b64_tr_b16 v[58:59], v25 offset:6656
    ds_read_b64_tr_b16 v[60:61], v24 offset:14336
    ds_read_b64_tr_b16 v[62:63], v24 offset:14848
    ds_read_b64_tr_b16 v[64:65], v25 offset:14336
    ds_read_b64_tr_b16 v[66:67], v25 offset:14848
    s_waitcnt lgkmcnt(9)
    v_mfma_f32_32x32x16_bf16 v[112:127], v[32:35], v[48:51], v[112:127]
    s_add_u32 s10, s11, 100352
    s_mov_b32 m0, s10
    s_add_u32 s14, s14, 14336
    buffer_load_dwordx4 v20, s[36:39], s14 offen lds
    v_mfma_f32_32x32x16_bf16 v[128:143], v[36:39], v[48:51], v[128:143]
    v_mfma_f32_32x32x16_bf16 v[144:159], v[40:43], v[48:51], v[144:159]
    s_add_u32 s10, s11, 101376
    s_mov_b32 m0, s10
    s_nop 0
    buffer_load_dwordx4 v21, s[36:39], s14 offen lds
    v_mfma_f32_32x32x16_bf16 v[160:175], v[44:47], v[48:51], v[160:175]
    s_waitcnt lgkmcnt(0)
    s_waitcnt vmcnt(6)
    s_barrier
    ds_read_b128 v[48:51], v100
    ds_read_b64_tr_b16 v[32:33], v26 offset:0
    ds_read_b64_tr_b16 v[34:35], v26 offset:512
    ds_read_b64_tr_b16 v[36:37], v27 offset:0
    ds_read_b64_tr_b16 v[38:39], v27 offset:512
    ds_read_b64_tr_b16 v[40:41], v26 offset:8192
    ds_read_b64_tr_b16 v[42:43], v26 offset:8704
    ds_read_b64_tr_b16 v[44:45], v27 offset:8192
    ds_read_b64_tr_b16 v[46:47], v27 offset:8704
    v_mfma_f32_32x32x16_bf16 v[112:127], v[52:55], v[68:71], v[112:127]
    v_mfma_f32_32x32x16_bf16 v[128:143], v[56:59], v[68:71], v[128:143]
    v_mfma_f32_32x32x16_bf16 v[144:159], v[60:63], v[68:71], v[144:159]
    v_mfma_f32_32x32x16_bf16 v[160:175], v[64:67], v[68:71], v[160:175]
    ds_read_b128 v[68:71], v101
    ds_read_b64_tr_b16 v[52:53], v26 offset:2048
    ds_read_b64_tr_b16 v[54:55], v26 offset:2560
    ds_read_b64_tr_b16 v[56:57], v27 offset:2048
    ds_read_b64_tr_b16 v[58:59], v27 offset:2560
    ds_read_b64_tr_b16 v[60:61], v26 offset:10240
    ds_read_b64_tr_b16 v[62:63], v26 offset:10752
    ds_read_b64_tr_b16 v[64:65], v27 offset:10240
    ds_read_b64_tr_b16 v[66:67], v27 offset:10752
    s_waitcnt lgkmcnt(9)
    v_mfma_f32_32x32x16_bf16 v[112:127], v[32:35], v[48:51], v[112:127]
    s_add_u32 s9, s7, 688128
    s_add_u32 s10, s8, 32768
    s_mov_b32 m0, s10
    s_add_u32 s10, s10, 8192
    buffer_load_dwordx4 v6, s[40:43], s9 offen lds
    v_mfma_f32_32x32x16_bf16 v[128:143], v[36:39], v[48:51], v[128:143]
    v_mfma_f32_32x32x16_bf16 v[144:159], v[40:43], v[48:51], v[144:159]
    s_mov_b32 m0, s10
    s_add_u32 s14, s6, 384
    buffer_load_dwordx4 v6, s[44:47], s9 offen lds
    v_mfma_f32_32x32x16_bf16 v[160:175], v[44:47], v[48:51], v[160:175]
    ds_read_b128 v[48:51], v102
    ds_read_b64_tr_b16 v[32:33], v26 offset:4096
    ds_read_b64_tr_b16 v[34:35], v26 offset:4608
    ds_read_b64_tr_b16 v[36:37], v27 offset:4096
    ds_read_b64_tr_b16 v[38:39], v27 offset:4608
    ds_read_b64_tr_b16 v[40:41], v26 offset:12288
    ds_read_b64_tr_b16 v[42:43], v26 offset:12800
    ds_read_b64_tr_b16 v[44:45], v27 offset:12288
    ds_read_b64_tr_b16 v[46:47], v27 offset:12800
    s_waitcnt lgkmcnt(9)
    v_mfma_f32_32x32x16_bf16 v[112:127], v[52:55], v[68:71], v[112:127]
    s_add_u32 s10, s11, 0
    s_mov_b32 m0, s10
    s_nop 0
    buffer_load_dwordx4 v20, s[36:39], s14 offen lds
    v_mfma_f32_32x32x16_bf16 v[128:143], v[56:59], v[68:71], v[128:143]
    v_mfma_f32_32x32x16_bf16 v[144:159], v[60:63], v[68:71], v[144:159]
    s_add_u32 s10, s11, 1024
    s_mov_b32 m0, s10
    s_nop 0
    buffer_load_dwordx4 v21, s[36:39], s14 offen lds
    v_mfma_f32_32x32x16_bf16 v[160:175], v[64:67], v[68:71], v[160:175]
    ds_read_b128 v[68:71], v103
    ds_read_b64_tr_b16 v[52:53], v26 offset:6144
    ds_read_b64_tr_b16 v[54:55], v26 offset:6656
    ds_read_b64_tr_b16 v[56:57], v27 offset:6144
    ds_read_b64_tr_b16 v[58:59], v27 offset:6656
    ds_read_b64_tr_b16 v[60:61], v26 offset:14336
    ds_read_b64_tr_b16 v[62:63], v26 offset:14848
    ds_read_b64_tr_b16 v[64:65], v27 offset:14336
    ds_read_b64_tr_b16 v[66:67], v27 offset:14848
    s_waitcnt lgkmcnt(9)
    v_mfma_f32_32x32x16_bf16 v[112:127], v[32:35], v[48:51], v[112:127]
    s_add_u32 s10, s11, 2048
    s_mov_b32 m0, s10
    s_add_u32 s14, s14, 14336
    buffer_load_dwordx4 v20, s[36:39], s14 offen lds
    v_mfma_f32_32x32x16_bf16 v[128:143], v[36:39], v[48:51], v[128:143]
    v_mfma_f32_32x32x16_bf16 v[144:159], v[40:43], v[48:51], v[144:159]
    s_add_u32 s10, s11, 3072
    s_mov_b32 m0, s10
    s_nop 0
    buffer_load_dwordx4 v21, s[36:39], s14 offen lds
    v_mfma_f32_32x32x16_bf16 v[160:175], v[44:47], v[48:51], v[160:175]
    s_waitcnt lgkmcnt(0)
    s_waitcnt vmcnt(6)
    s_barrier
    ds_read_b128 v[48:51], v104
    ds_read_b64_tr_b16 v[32:33], v28 offset:0
    ds_read_b64_tr_b16 v[34:35], v28 offset:512
    ds_read_b64_tr_b16 v[36:37], v29 offset:0
    ds_read_b64_tr_b16 v[38:39], v29 offset:512
    ds_read_b64_tr_b16 v[40:41], v28 offset:8192
    ds_read_b64_tr_b16 v[42:43], v28 offset:8704
    ds_read_b64_tr_b16 v[44:45], v29 offset:8192
    ds_read_b64_tr_b16 v[46:47], v29 offset:8704
    v_mfma_f32_32x32x16_bf16 v[112:127], v[52:55], v[68:71], v[112:127]
    v_mfma_f32_32x32x16_bf16 v[128:143], v[56:59], v[68:71], v[128:143]
    v_mfma_f32_32x32x16_bf16 v[144:159], v[60:63], v[68:71], v[144:159]
    v_mfma_f32_32x32x16_bf16 v[160:175], v[64:67], v[68:71], v[160:175]
    ds_read_b128 v[68:71], v105
    ds_read_b64_tr_b16 v[52:53], v28 offset:2048
    ds_read_b64_tr_b16 v[54:55], v28 offset:2560
    ds_read_b64_tr_b16 v[56:57], v29 offset:2048
    ds_read_b64_tr_b16 v[58:59], v29 offset:2560
    ds_read_b64_tr_b16 v[60:61], v28 offset:10240
    ds_read_b64_tr_b16 v[62:63], v28 offset:10752
    ds_read_b64_tr_b16 v[64:65], v29 offset:10240
    ds_read_b64_tr_b16 v[66:67], v29 offset:10752
    s_waitcnt lgkmcnt(9)
    v_mfma_f32_32x32x16_bf16 v[112:127], v[32:35], v[48:51], v[112:127]
    s_add_u32 s9, s7, 917504
    s_add_u32 s10, s8, 81920
    s_mov_b32 m0, s10
    s_add_u32 s10, s10, 8192
    buffer_load_dwordx4 v6, s[40:43], s9 offen lds
    v_mfma_f32_32x32x16_bf16 v[128:143], v[36:39], v[48:51], v[128:143]
    v_mfma_f32_32x32x16_bf16 v[144:159], v[40:43], v[48:51], v[144:159]
    s_mov_b32 m0, s10
    s_add_u32 s14, s6, 512
    buffer_load_dwordx4 v6, s[44:47], s9 offen lds
    v_mfma_f32_32x32x16_bf16 v[160:175], v[44:47], v[48:51], v[160:175]
    ds_read_b128 v[48:51], v106
    ds_read_b64_tr_b16 v[32:33], v28 offset:4096
    ds_read_b64_tr_b16 v[34:35], v28 offset:4608
    ds_read_b64_tr_b16 v[36:37], v29 offset:4096
    ds_read_b64_tr_b16 v[38:39], v29 offset:4608
    ds_read_b64_tr_b16 v[40:41], v28 offset:12288
    ds_read_b64_tr_b16 v[42:43], v28 offset:12800
    ds_read_b64_tr_b16 v[44:45], v29 offset:12288
    ds_read_b64_tr_b16 v[46:47], v29 offset:12800
    s_waitcnt lgkmcnt(9)
    v_mfma_f32_32x32x16_bf16 v[112:127], v[52:55], v[68:71], v[112:127]
    s_add_u32 s10, s11, 49152
    s_mov_b32 m0, s10
    s_nop 0
    buffer_load_dwordx4 v20, s[36:39], s14 offen lds
    v_mfma_f32_32x32x16_bf16 v[128:143], v[56:59], v[68:71], v[128:143]
    v_mfma_f32_32x32x16_bf16 v[144:159], v[60:63], v[68:71], v[144:159]
    s_add_u32 s10, s11, 50176
    s_mov_b32 m0, s10
    s_nop 0
    buffer_load_dwordx4 v21, s[36:39], s14 offen lds
    v_mfma_f32_32x32x16_bf16 v[160:175], v[64:67], v[68:71], v[160:175]
    ds_read_b128 v[68:71], v107
    ds_read_b64_tr_b16 v[52:53], v28 offset:6144
    ds_read_b64_tr_b16 v[54:55], v28 offset:6656
    ds_read_b64_tr_b16 v[56:57], v29 offset:6144
    ds_read_b64_tr_b16 v[58:59], v29 offset:6656
    ds_read_b64_tr_b16 v[60:61], v28 offset:14336
    ds_read_b64_tr_b16 v[62:63], v28 offset:14848
    ds_read_b64_tr_b16 v[64:65], v29 offset:14336
    ds_read_b64_tr_b16 v[66:67], v29 offset:14848
    s_waitcnt lgkmcnt(9)
    v_mfma_f32_32x32x16_bf16 v[112:127], v[32:35], v[48:51], v[112:127]
    s_add_u32 s10, s11, 51200
    s_mov_b32 m0, s10
    s_add_u32 s14, s14, 14336
    buffer_load_dwordx4 v20, s[36:39], s14 offen lds
    v_mfma_f32_32x32x16_bf16 v[128:143], v[36:39], v[48:51], v[128:143]
    v_mfma_f32_32x32x16_bf16 v[144:159], v[40:43], v[48:51], v[144:159]
    s_add_u32 s10, s11, 52224
    s_mov_b32 m0, s10
    s_nop 0
    buffer_load_dwordx4 v21, s[36:39], s14 offen lds
    v_mfma_f32_32x32x16_bf16 v[160:175], v[44:47], v[48:51], v[160:175]
    s_waitcnt lgkmcnt(0)
    s_waitcnt vmcnt(6)
    s_barrier
    ds_read_b128 v[48:51], v96
    ds_read_b64_tr_b16 v[32:33], v24 offset:0
    ds_read_b64_tr_b16 v[34:35], v24 offset:512
    ds_read_b64_tr_b16 v[36:37], v25 offset:0
    ds_read_b64_tr_b16 v[38:39], v25 offset:512
    ds_read_b64_tr_b16 v[40:41], v24 offset:8192
    ds_read_b64_tr_b16 v[42:43], v24 offset:8704
    ds_read_b64_tr_b16 v[44:45], v25 offset:8192
    ds_read_b64_tr_b16 v[46:47], v25 offset:8704
    v_mfma_f32_32x32x16_bf16 v[112:127], v[52:55], v[68:71], v[112:127]
    v_mfma_f32_32x32x16_bf16 v[128:143], v[56:59], v[68:71], v[128:143]
    v_mfma_f32_32x32x16_bf16 v[144:159], v[60:63], v[68:71], v[144:159]
    v_mfma_f32_32x32x16_bf16 v[160:175], v[64:67], v[68:71], v[160:175]
    ds_read_b128 v[68:71], v97
    ds_read_b64_tr_b16 v[52:53], v24 offset:2048
    ds_read_b64_tr_b16 v[54:55], v24 offset:2560
    ds_read_b64_tr_b16 v[56:57], v25 offset:2048
    ds_read_b64_tr_b16 v[58:59], v25 offset:2560
    ds_read_b64_tr_b16 v[60:61], v24 offset:10240
    ds_read_b64_tr_b16 v[62:63], v24 offset:10752
    ds_read_b64_tr_b16 v[64:65], v25 offset:10240
    ds_read_b64_tr_b16 v[66:67], v25 offset:10752
    s_waitcnt lgkmcnt(9)
    v_mfma_f32_32x32x16_bf16 v[112:127], v[32:35], v[48:51], v[112:127]
    s_add_u32 s9, s7, 1146880
    s_add_u32 s10, s8, 131072
    s_mov_b32 m0, s10
    s_add_u32 s10, s10, 8192
    buffer_load_dwordx4 v6, s[40:43], s9 offen lds
    v_mfma_f32_32x32x16_bf16 v[128:143], v[36:39], v[48:51], v[128:143]
    v_mfma_f32_32x32x16_bf16 v[144:159], v[40:43], v[48:51], v[144:159]
    s_mov_b32 m0, s10
    s_add_u32 s14, s6, 640
    buffer_load_dwordx4 v6, s[44:47], s9 offen lds
    v_mfma_f32_32x32x16_bf16 v[160:175], v[44:47], v[48:51], v[160:175]
    ds_read_b128 v[48:51], v98
    ds_read_b64_tr_b16 v[32:33], v24 offset:4096
    ds_read_b64_tr_b16 v[34:35], v24 offset:4608
    ds_read_b64_tr_b16 v[36:37], v25 offset:4096
    ds_read_b64_tr_b16 v[38:39], v25 offset:4608
    ds_read_b64_tr_b16 v[40:41], v24 offset:12288
    ds_read_b64_tr_b16 v[42:43], v24 offset:12800
    ds_read_b64_tr_b16 v[44:45], v25 offset:12288
    ds_read_b64_tr_b16 v[46:47], v25 offset:12800
    s_waitcnt lgkmcnt(9)
    v_mfma_f32_32x32x16_bf16 v[112:127], v[52:55], v[68:71], v[112:127]
    s_add_u32 s10, s11, 98304
    s_mov_b32 m0, s10
    s_nop 0
    buffer_load_dwordx4 v20, s[36:39], s14 offen lds
    v_mfma_f32_32x32x16_bf16 v[128:143], v[56:59], v[68:71], v[128:143]
    v_mfma_f32_32x32x16_bf16 v[144:159], v[60:63], v[68:71], v[144:159]
    s_add_u32 s10, s11, 99328
    s_mov_b32 m0, s10
    s_nop 0
    buffer_load_dwordx4 v21, s[36:39], s14 offen lds
    v_mfma_f32_32x32x16_bf16 v[160:175], v[64:67], v[68:71], v[160:175]
    ds_read_b128 v[68:71], v99
    ds_read_b64_tr_b16 v[52:53], v24 offset:6144
    ds_read_b64_tr_b16 v[54:55], v24 offset:6656
    ds_read_b64_tr_b16 v[56:57], v25 offset:6144
    ds_read_b64_tr_b16 v[58:59], v25 offset:6656
    ds_read_b64_tr_b16 v[60:61], v24 offset:14336
    ds_read_b64_tr_b16 v[62:63], v24 offset:14848
    ds_read_b64_tr_b16 v[64:65], v25 offset:14336
    ds_read_b64_tr_b16 v[66:67], v25 offset:14848
    s_waitcnt lgkmcnt(9)
    v_mfma_f32_32x32x16_bf16 v[112:127], v[32:35], v[48:51], v[112:127]
    s_add_u32 s10, s11, 100352
    s_mov_b32 m0, s10
    s_add_u32 s14, s14, 14336
    buffer_load_dwordx4 v20, s[36:39], s14 offen lds
    v_mfma_f32_32x32x16_bf16 v[128:143], v[36:39], v[48:51], v[128:143]
    v_mfma_f32_32x32x16_bf16 v[144:159], v[40:43], v[48:51], v[144:159]
    s_add_u32 s10, s11, 101376
    s_mov_b32 m0, s10
    s_nop 0
    buffer_load_dwordx4 v21, s[36:39], s14 offen lds
    v_mfma_f32_32x32x16_bf16 v[160:175], v[44:47], v[48:51], v[160:175]
    s_waitcnt lgkmcnt(0)
    s_waitcnt vmcnt(6)
    s_barrier
    ds_read_b128 v[48:51], v100
    ds_read_b64_tr_b16 v[32:33], v26 offset:0
    ds_read_b64_tr_b16 v[34:35], v26 offset:512
    ds_read_b64_tr_b16 v[36:37], v27 offset:0
    ds_read_b64_tr_b16 v[38:39], v27 offset:512
    ds_read_b64_tr_b16 v[40:41], v26 offset:8192
    ds_read_b64_tr_b16 v[42:43], v26 offset:8704
    ds_read_b64_tr_b16 v[44:45], v27 offset:8192
    ds_read_b64_tr_b16 v[46:47], v27 offset:8704
    v_mfma_f32_32x32x16_bf16 v[112:127], v[52:55], v[68:71], v[112:127]
    v_mfma_f32_32x32x16_bf16 v[128:143], v[56:59], v[68:71], v[128:143]
    v_mfma_f32_32x32x16_bf16 v[144:159], v[60:63], v[68:71], v[144:159]
    v_mfma_f32_32x32x16_bf16 v[160:175], v[64:67], v[68:71], v[160:175]
    ds_read_b128 v[68:71], v101
    ds_read_b64_tr_b16 v[52:53], v26 offset:2048
    ds_read_b64_tr_b16 v[54:55], v26 offset:2560
    ds_read_b64_tr_b16 v[56:57], v27 offset:2048
    ds_read_b64_tr_b16 v[58:59], v27 offset:2560
    ds_read_b64_tr_b16 v[60:61], v26 offset:10240
    ds_read_b64_tr_b16 v[62:63], v26 offset:10752
    ds_read_b64_tr_b16 v[64:65], v27 offset:10240
    ds_read_b64_tr_b16 v[66:67], v27 offset:10752
    s_waitcnt lgkmcnt(9)
    v_mfma_f32_32x32x16_bf16 v[112:127], v[32:35], v[48:51], v[112:127]
    s_add_u32 s9, s7, 1376256
    s_add_u32 s10, s8, 32768
    s_mov_b32 m0, s10
    s_add_u32 s10, s10, 8192
    buffer_load_dwordx4 v6, s[40:43], s9 offen lds
    v_mfma_f32_32x32x16_bf16 v[128:143], v[36:39], v[48:51], v[128:143]
    v_mfma_f32_32x32x16_bf16 v[144:159], v[40:43], v[48:51], v[144:159]
    s_mov_b32 m0, s10
    s_add_u32 s14, s6, 768
    buffer_load_dwordx4 v6, s[44:47], s9 offen lds
    v_mfma_f32_32x32x16_bf16 v[160:175], v[44:47], v[48:51], v[160:175]
    ds_read_b128 v[48:51], v102
    ds_read_b64_tr_b16 v[32:33], v26 offset:4096
    ds_read_b64_tr_b16 v[34:35], v26 offset:4608
    ds_read_b64_tr_b16 v[36:37], v27 offset:4096
    ds_read_b64_tr_b16 v[38:39], v27 offset:4608
    ds_read_b64_tr_b16 v[40:41], v26 offset:12288
    ds_read_b64_tr_b16 v[42:43], v26 offset:12800
    ds_read_b64_tr_b16 v[44:45], v27 offset:12288
    ds_read_b64_tr_b16 v[46:47], v27 offset:12800
    s_waitcnt lgkmcnt(9)
    v_mfma_f32_32x32x16_bf16 v[112:127], v[52:55], v[68:71], v[112:127]
    s_add_u32 s10, s11, 0
    s_mov_b32 m0, s10
    s_nop 0
    buffer_load_dwordx4 v20, s[36:39], s14 offen lds
    v_mfma_f32_32x32x16_bf16 v[128:143], v[56:59], v[68:71], v[128:143]
    v_mfma_f32_32x32x16_bf16 v[144:159], v[60:63], v[68:71], v[144:159]
    s_add_u32 s10, s11, 1024
    s_mov_b32 m0, s10
    s_nop 0
    buffer_load_dwordx4 v21, s[36:39], s14 offen lds
    v_mfma_f32_32x32x16_bf16 v[160:175], v[64:67], v[68:71], v[160:175]
    ds_read_b128 v[68:71], v103
    ds_read_b64_tr_b16 v[52:53], v26 offset:6144
    ds_read_b64_tr_b16 v[54:55], v26 offset:6656
    ds_read_b64_tr_b16 v[56:57], v27 offset:6144
    ds_read_b64_tr_b16 v[58:59], v27 offset:6656
    ds_read_b64_tr_b16 v[60:61], v26 offset:14336
    ds_read_b64_tr_b16 v[62:63], v26 offset:14848
    ds_read_b64_tr_b16 v[64:65], v27 offset:14336
    ds_read_b64_tr_b16 v[66:67], v27 offset:14848
    s_waitcnt lgkmcnt(9)
    v_mfma_f32_32x32x16_bf16 v[112:127], v[32:35], v[48:51], v[112:127]
    s_add_u32 s10, s11, 2048
    s_mov_b32 m0, s10
    s_add_u32 s14, s14, 14336
    buffer_load_dwordx4 v20, s[36:39], s14 offen lds
    v_mfma_f32_32x32x16_bf16 v[128:143], v[36:39], v[48:51], v[128:143]
    v_mfma_f32_32x32x16_bf16 v[144:159], v[40:43], v[48:51], v[144:159]
    s_add_u32 s10, s11, 3072
    s_mov_b32 m0, s10
    s_nop 0
    buffer_load_dwordx4 v21, s[36:39], s14 offen lds
    v_mfma_f32_32x32x16_bf16 v[160:175], v[44:47], v[48:51], v[160:175]
    s_waitcnt lgkmcnt(0)
    s_waitcnt vmcnt(6)
    s_barrier
    ds_read_b128 v[48:51], v104
    ds_read_b64_tr_b16 v[32:33], v28 offset:0
    ds_read_b64_tr_b16 v[34:35], v28 offset:512
    ds_read_b64_tr_b16 v[36:37], v29 offset:0
    ds_read_b64_tr_b16 v[38:39], v29 offset:512
    ds_read_b64_tr_b16 v[40:41], v28 offset:8192
    ds_read_b64_tr_b16 v[42:43], v28 offset:8704
    ds_read_b64_tr_b16 v[44:45], v29 offset:8192
    ds_read_b64_tr_b16 v[46:47], v29 offset:8704
    v_mfma_f32_32x32x16_bf16 v[112:127], v[52:55], v[68:71], v[112:127]
    v_mfma_f32_32x32x16_bf16 v[128:143], v[56:59], v[68:71], v[128:143]
    v_mfma_f32_32x32x16_bf16 v[144:159], v[60:63], v[68:71], v[144:159]
    v_mfma_f32_32x32x16_bf16 v[160:175], v[64:67], v[68:71], v[160:175]
    ds_read_b128 v[68:71], v105
    ds_read_b64_tr_b16 v[52:53], v28 offset:2048
    ds_read_b64_tr_b16 v[54:55], v28 offset:2560
    ds_read_b64_tr_b16 v[56:57], v29 offset:2048
    ds_read_b64_tr_b16 v[58:59], v29 offset:2560
    ds_read_b64_tr_b16 v[60:61], v28 offset:10240
    ds_read_b64_tr_b16 v[62:63], v28 offset:10752
    ds_read_b64_tr_b16 v[64:65], v29 offset:10240
    ds_read_b64_tr_b16 v[66:67], v29 offset:10752
    s_waitcnt lgkmcnt(9)
    v_mfma_f32_32x32x16_bf16 v[112:127], v[32:35], v[48:51], v[112:127]
    v_mfma_f32_32x32x16_bf16 v[128:143], v[36:39], v[48:51], v[128:143]
    v_mfma_f32_32x32x16_bf16 v[144:159], v[40:43], v[48:51], v[144:159]
    v_mfma_f32_32x32x16_bf16 v[160:175], v[44:47], v[48:51], v[160:175]
    ds_read_b128 v[48:51], v106
    ds_read_b64_tr_b16 v[32:33], v28 offset:4096
    ds_read_b64_tr_b16 v[34:35], v28 offset:4608
    ds_read_b64_tr_b16 v[36:37], v29 offset:4096
    ds_read_b64_tr_b16 v[38:39], v29 offset:4608
    ds_read_b64_tr_b16 v[40:41], v28 offset:12288
    ds_read_b64_tr_b16 v[42:43], v28 offset:12800
    ds_read_b64_tr_b16 v[44:45], v29 offset:12288
    ds_read_b64_tr_b16 v[46:47], v29 offset:12800
    s_waitcnt lgkmcnt(9)
    v_mfma_f32_32x32x16_bf16 v[112:127], v[52:55], v[68:71], v[112:127]
    v_mfma_f32_32x32x16_bf16 v[128:143], v[56:59], v[68:71], v[128:143]
    v_mfma_f32_32x32x16_bf16 v[144:159], v[60:63], v[68:71], v[144:159]
    v_mfma_f32_32x32x16_bf16 v[160:175], v[64:67], v[68:71], v[160:175]
    ds_read_b128 v[68:71], v107
    ds_read_b64_tr_b16 v[52:53], v28 offset:6144
    ds_read_b64_tr_b16 v[54:55], v28 offset:6656
    ds_read_b64_tr_b16 v[56:57], v29 offset:6144
    ds_read_b64_tr_b16 v[58:59], v29 offset:6656
    ds_read_b64_tr_b16 v[60:61], v28 offset:14336
    ds_read_b64_tr_b16 v[62:63], v28 offset:14848
    ds_read_b64_tr_b16 v[64:65], v29 offset:14336
    ds_read_b64_tr_b16 v[66:67], v29 offset:14848
    s_waitcnt lgkmcnt(9)
    v_mfma_f32_32x32x16_bf16 v[112:127], v[32:35], v[48:51], v[112:127]
    v_mfma_f32_32x32x16_bf16 v[128:143], v[36:39], v[48:51], v[128:143]
    v_mfma_f32_32x32x16_bf16 v[144:159], v[40:43], v[48:51], v[144:159]
    v_mfma_f32_32x32x16_bf16 v[160:175], v[44:47], v[48:51], v[160:175]
    s_waitcnt lgkmcnt(0)
    s_waitcnt vmcnt(0)
    s_barrier
    ds_read_b128 v[48:51], v96
    ds_read_b64_tr_b16 v[32:33], v24 offset:0
    ds_read_b64_tr_b16 v[34:35], v24 offset:512
    ds_read_b64_tr_b16 v[36:37], v25 offset:0
    ds_read_b64_tr_b16 v[38:39], v25 offset:512
    ds_read_b64_tr_b16 v[40:41], v24 offset:8192
    ds_read_b64_tr_b16 v[42:43], v24 offset:8704
    ds_read_b64_tr_b16 v[44:45], v25 offset:8192
    ds_read_b64_tr_b16 v[46:47], v25 offset:8704
    v_mfma_f32_32x32x16_bf16 v[112:127], v[52:55], v[68:71], v[112:127]
    v_mfma_f32_32x32x16_bf16 v[128:143], v[56:59], v[68:71], v[128:143]
    v_mfma_f32_32x32x16_bf16 v[144:159], v[60:63], v[68:71], v[144:159]
    v_mfma_f32_32x32x16_bf16 v[160:175], v[64:67], v[68:71], v[160:175]
    ds_read_b128 v[68:71], v97
    ds_read_b64_tr_b16 v[52:53], v24 offset:2048
    ds_read_b64_tr_b16 v[54:55], v24 offset:2560
    ds_read_b64_tr_b16 v[56:57], v25 offset:2048
    ds_read_b64_tr_b16 v[58:59], v25 offset:2560
    ds_read_b64_tr_b16 v[60:61], v24 offset:10240
    ds_read_b64_tr_b16 v[62:63], v24 offset:10752
    ds_read_b64_tr_b16 v[64:65], v25 offset:10240
    ds_read_b64_tr_b16 v[66:67], v25 offset:10752
    s_waitcnt lgkmcnt(9)
    v_mfma_f32_32x32x16_bf16 v[112:127], v[32:35], v[48:51], v[112:127]
    v_mfma_f32_32x32x16_bf16 v[128:143], v[36:39], v[48:51], v[128:143]
    v_mfma_f32_32x32x16_bf16 v[144:159], v[40:43], v[48:51], v[144:159]
    v_mfma_f32_32x32x16_bf16 v[160:175], v[44:47], v[48:51], v[160:175]
    ds_read_b128 v[48:51], v98
    ds_read_b64_tr_b16 v[32:33], v24 offset:4096
    ds_read_b64_tr_b16 v[34:35], v24 offset:4608
    ds_read_b64_tr_b16 v[36:37], v25 offset:4096
    ds_read_b64_tr_b16 v[38:39], v25 offset:4608
    ds_read_b64_tr_b16 v[40:41], v24 offset:12288
    ds_read_b64_tr_b16 v[42:43], v24 offset:12800
    ds_read_b64_tr_b16 v[44:45], v25 offset:12288
    ds_read_b64_tr_b16 v[46:47], v25 offset:12800
    s_waitcnt lgkmcnt(9)
    v_mfma_f32_32x32x16_bf16 v[112:127], v[52:55], v[68:71], v[112:127]
    v_mfma_f32_32x32x16_bf16 v[128:143], v[56:59], v[68:71], v[128:143]
    v_mfma_f32_32x32x16_bf16 v[144:159], v[60:63], v[68:71], v[144:159]
    v_mfma_f32_32x32x16_bf16 v[160:175], v[64:67], v[68:71], v[160:175]
    ds_read_b128 v[68:71], v99
    ds_read_b64_tr_b16 v[52:53], v24 offset:6144
    ds_read_b64_tr_b16 v[54:55], v24 offset:6656
    ds_read_b64_tr_b16 v[56:57], v25 offset:6144
    ds_read_b64_tr_b16 v[58:59], v25 offset:6656
    ds_read_b64_tr_b16 v[60:61], v24 offset:14336
    ds_read_b64_tr_b16 v[62:63], v24 offset:14848
    ds_read_b64_tr_b16 v[64:65], v25 offset:14336
    ds_read_b64_tr_b16 v[66:67], v25 offset:14848
    s_waitcnt lgkmcnt(9)
    v_mfma_f32_32x32x16_bf16 v[112:127], v[32:35], v[48:51], v[112:127]
    v_mfma_f32_32x32x16_bf16 v[128:143], v[36:39], v[48:51], v[128:143]
    v_mfma_f32_32x32x16_bf16 v[144:159], v[40:43], v[48:51], v[144:159]
    v_mfma_f32_32x32x16_bf16 v[160:175], v[44:47], v[48:51], v[160:175]
    s_waitcnt lgkmcnt(0)
    v_mfma_f32_32x32x16_bf16 v[112:127], v[52:55], v[68:71], v[112:127]
    v_mfma_f32_32x32x16_bf16 v[128:143], v[56:59], v[68:71], v[128:143]
    v_mfma_f32_32x32x16_bf16 v[144:159], v[60:63], v[68:71], v[144:159]
    v_mfma_f32_32x32x16_bf16 v[160:175], v[64:67], v[68:71], v[160:175]
    s_nop 13
    v_mov_b32 v40, 0xbdd2d3e8
    v_mov_b32 v41, 0xbdd2d3e8
    v_mov_b32 v42, 0xc0135761
    v_mov_b32 v43, 0xc0135761
    v_mul_u32_u24 v5, 3712, v3
    v_lshl_add_u32 v5, v4, 5, v5
    s_mul_i32 s15, s4, 950272
    s_add_u32 s15, s15, s7
    v_cvt_pk_bf16_f32 v32, v112, v113
    v_cvt_pk_bf16_f32 v33, v144, v145
    v_lshlrev_b32 v112, 16, v32
    v_and_b32 v113, 0xffff0000, v32
    v_lshlrev_b32 v144, 16, v33
    v_and_b32 v145, 0xffff0000, v33
    v_pk_mul_f32 v[34:35], v[112:113], v[112:113]
    v_pk_fma_f32 v[34:35], v[34:35], v[40:41], v[42:43]
    v_pk_mul_f32 v[34:35], v[34:35], v[112:113]
    v_exp_f32 v34, v34
    v_exp_f32 v35, v35
    s_nop 0
    v_pk_add_f32 v[34:35], v[34:35], 1.0 op_sel_hi:[1,0]
    v_rcp_f32 v34, v34
    v_rcp_f32 v35, v35
    s_nop 0
    v_pk_mul_f32 v[34:35], v[34:35], v[112:113]
    v_cvt_pk_bf16_f32 v32, v34, v35
    v_lshlrev_b32 v34, 16, v32
    v_and_b32 v35, 0xffff0000, v32
    v_pk_mul_f32 v[34:35], v[34:35], v[144:145]
    v_cvt_pk_bf16_f32 v64, v34, v35
    v_cvt_pk_bf16_f32 v32, v114, v115
    v_cvt_pk_bf16_f32 v33, v146, v147
    v_lshlrev_b32 v114, 16, v32
    v_and_b32 v115, 0xffff0000, v32
    v_lshlrev_b32 v146, 16, v33
    v_and_b32 v147, 0xffff0000, v33
    v_pk_mul_f32 v[34:35], v[114:115], v[114:115]
    v_pk_fma_f32 v[34:35], v[34:35], v[40:41], v[42:43]
    v_pk_mul_f32 v[34:35], v[34:35], v[114:115]
    v_exp_f32 v34, v34
    v_exp_f32 v35, v35
    s_nop 0
    v_pk_add_f32 v[34:35], v[34:35], 1.0 op_sel_hi:[1,0]
    v_rcp_f32 v34, v34
    v_rcp_f32 v35, v35
    s_nop 0
    v_pk_mul_f32 v[34:35], v[34:35], v[114:115]
    v_cvt_pk_bf16_f32 v32, v34, v35
    v_lshlrev_b32 v34, 16, v32
    v_and_b32 v35, 0xffff0000, v32
    v_pk_mul_f32 v[34:35], v[34:35], v[146:147]
    v_cvt_pk_bf16_f32 v65, v34, v35
    v_cvt_pk_bf16_f32 v32, v116, v117
    v_cvt_pk_bf16_f32 v33, v148, v149
    v_lshlrev_b32 v116, 16, v32
    v_and_b32 v117, 0xffff0000, v32
    v_lshlrev_b32 v148, 16, v33
    v_and_b32 v149, 0xffff0000, v33
    v_pk_mul_f32 v[34:35], v[116:117], v[116:117]
    v_pk_fma_f32 v[34:35], v[34:35], v[40:41], v[42:43]
    v_pk_mul_f32 v[34:35], v[34:35], v[116:117]
    v_exp_f32 v34, v34
    v_exp_f32 v35, v35
    s_nop 0
    v_pk_add_f32 v[34:35], v[34:35], 1.0 op_sel_hi:[1,0]
    v_rcp_f32 v34, v34
    v_rcp_f32 v35, v35
    s_nop 0
    v_pk_mul_f32 v[34:35], v[34:35], v[116:117]
    v_cvt_pk_bf16_f32 v32, v34, v35
    v_lshlrev_b32 v34, 16, v32
    v_and_b32 v35, 0xffff0000, v32
    v_pk_mul_f32 v[34:35], v[34:35], v[148:149]
    v_cvt_pk_bf16_f32 v66, v34, v35
    v_cvt_pk_bf16_f32 v32, v118, v119
    v_cvt_pk_bf16_f32 v33, v150, v151
    v_lshlrev_b32 v118, 16, v32
    v_and_b32 v119, 0xffff0000, v32
    v_lshlrev_b32 v150, 16, v33
    v_and_b32 v151, 0xffff0000, v33
    v_pk_mul_f32 v[34:35], v[118:119], v[118:119]
    v_pk_fma_f32 v[34:35], v[34:35], v[40:41], v[42:43]
    v_pk_mul_f32 v[34:35], v[34:35], v[118:119]
    v_exp_f32 v34, v34
    v_exp_f32 v35, v35
    s_nop 0
    v_pk_add_f32 v[34:35], v[34:35], 1.0 op_sel_hi:[1,0]
    v_rcp_f32 v34, v34
    v_rcp_f32 v35, v35
    s_nop 0
    v_pk_mul_f32 v[34:35], v[34:35], v[118:119]
    v_cvt_pk_bf16_f32 v32, v34, v35
    v_lshlrev_b32 v34, 16, v32
    v_and_b32 v35, 0xffff0000, v32
    v_pk_mul_f32 v[34:35], v[34:35], v[150:151]
    v_cvt_pk_bf16_f32 v67, v34, v35
    v_cvt_pk_bf16_f32 v32, v120, v121
    v_cvt_pk_bf16_f32 v33, v152, v153
    v_lshlrev_b32 v120, 16, v32
    v_and_b32 v121, 0xffff0000, v32
    v_lshlrev_b32 v152, 16, v33
    v_and_b32 v153, 0xffff0000, v33
    v_pk_mul_f32 v[34:35], v[120:121], v[120:121]
    v_pk_fma_f32 v[34:35], v[34:35], v[40:41], v[42:43]
    v_pk_mul_f32 v[34:35], v[34:35], v[120:121]
    v_exp_f32 v34, v34
    v_exp_f32 v35, v35
    s_nop 0
    v_pk_add_f32 v[34:35], v[34:35], 1.0 op_sel_hi:[1,0]
    v_rcp_f32 v34, v34
    v_rcp_f32 v35, v35
    s_nop 0
    v_pk_mul_f32 v[34:35], v[34:35], v[120:121]
    v_cvt_pk_bf16_f32 v32, v34, v35
    v_lshlrev_b32 v34, 16, v32
    v_and_b32 v35, 0xffff0000, v32
    v_pk_mul_f32 v[34:35], v[34:35], v[152:153]
    v_cvt_pk_bf16_f32 v68, v34, v35
    v_cvt_pk_bf16_f32 v32, v122, v123
    v_cvt_pk_bf16_f32 v33, v154, v155
    v_lshlrev_b32 v122, 16, v32
    v_and_b32 v123, 0xffff0000, v32
    v_lshlrev_b32 v154, 16, v33
    v_and_b32 v155, 0xffff0000, v33
    v_pk_mul_f32 v[34:35], v[122:123], v[122:123]
    v_pk_fma_f32 v[34:35], v[34:35], v[40:41], v[42:43]
    v_pk_mul_f32 v[34:35], v[34:35], v[122:123]
    v_exp_f32 v34, v34
    v_exp_f32 v35, v35
    s_nop 0
    v_pk_add_f32 v[34:35], v[34:35], 1.0 op_sel_hi:[1,0]
    v_rcp_f32 v34, v34
    v_rcp_f32 v35, v35
    s_nop 0
    v_pk_mul_f32 v[34:35], v[34:35], v[122:123]
    v_cvt_pk_bf16_f32 v32, v34, v35
    v_lshlrev_b32 v34, 16, v32
    v_and_b32 v35, 0xffff0000, v32
    v_pk_mul_f32 v[34:35], v[34:35], v[154:155]
    v_cvt_pk_bf16_f32 v69, v34, v35
    v_cvt_pk_bf16_f32 v32, v124, v125
    v_cvt_pk_bf16_f32 v33, v156, v157
    v_lshlrev_b32 v124, 16, v32
    v_and_b32 v125, 0xffff0000, v32
    v_lshlrev_b32 v156, 16, v33
    v_and_b32 v157, 0xffff0000, v33
    v_pk_mul_f32 v[34:35], v[124:125], v[124:125]
    v_pk_fma_f32 v[34:35], v[34:35], v[40:41], v[42:43]
    v_pk_mul_f32 v[34:35], v[34:35], v[124:125]
    v_exp_f32 v34, v34
    v_exp_f32 v35, v35
    s_nop 0
    v_pk_add_f32 v[34:35], v[34:35], 1.0 op_sel_hi:[1,0]
    v_rcp_f32 v34, v34
    v_rcp_f32 v35, v35
    s_nop 0
    v_pk_mul_f32 v[34:35], v[34:35], v[124:125]
    v_cvt_pk_bf16_f32 v32, v34, v35
    v_lshlrev_b32 v34, 16, v32
    v_and_b32 v35, 0xffff0000, v32
    v_pk_mul_f32 v[34:35], v[34:35], v[156:157]
    v_cvt_pk_bf16_f32 v70, v34, v35
    v_cvt_pk_bf16_f32 v32, v126, v127
    v_cvt_pk_bf16_f32 v33, v158, v159
    v_lshlrev_b32 v126, 16, v32
    v_and_b32 v127, 0xffff0000, v32
    v_lshlrev_b32 v158, 16, v33
    v_and_b32 v159, 0xffff0000, v33
    v_pk_mul_f32 v[34:35], v[126:127], v[126:127]
    v_pk_fma_f32 v[34:35], v[34:35], v[40:41], v[42:43]
    v_pk_mul_f32 v[34:35], v[34:35], v[126:127]
    v_exp_f32 v34, v34
    v_exp_f32 v35, v35
    s_nop 0
    v_pk_add_f32 v[34:35], v[34:35], 1.0 op_sel_hi:[1,0]
    v_rcp_f32 v34, v34
    v_rcp_f32 v35, v35
    s_nop 0
    v_pk_mul_f32 v[34:35], v[34:35], v[126:127]
    v_cvt_pk_bf16_f32 v32, v34, v35
    v_lshlrev_b32 v34, 16, v32
    v_and_b32 v35, 0xffff0000, v32
    v_pk_mul_f32 v[34:35], v[34:35], v[158:159]
    v_cvt_pk_bf16_f32 v71, v34, v35
    buffer_store_dwordx4 v[64:67], v5, s[48:51], s15 offen offset:0
    buffer_store_dwordx4 v[68:71], v5, s[48:51], s15 offen offset:16
    v_cvt_pk_bf16_f32 v32, v128, v129
    v_cvt_pk_bf16_f32 v33, v160, v161
    v_lshlrev_b32 v128, 16, v32
    v_and_b32 v129, 0xffff0000, v32
    v_lshlrev_b32 v160, 16, v33
    v_and_b32 v161, 0xffff0000, v33
    v_pk_mul_f32 v[34:35], v[128:129], v[128:129]
    v_pk_fma_f32 v[34:35], v[34:35], v[40:41], v[42:43]
    v_pk_mul_f32 v[34:35], v[34:35], v[128:129]
    v_exp_f32 v34, v34
    v_exp_f32 v35, v35
    s_nop 0
    v_pk_add_f32 v[34:35], v[34:35], 1.0 op_sel_hi:[1,0]
    v_rcp_f32 v34, v34
    v_rcp_f32 v35, v35
    s_nop 0
    v_pk_mul_f32 v[34:35], v[34:35], v[128:129]
    v_cvt_pk_bf16_f32 v32, v34, v35
    v_lshlrev_b32 v34, 16, v32
    v_and_b32 v35, 0xffff0000, v32
    v_pk_mul_f32 v[34:35], v[34:35], v[160:161]
    v_cvt_pk_bf16_f32 v72, v34, v35
    v_cvt_pk_bf16_f32 v32, v130, v131
    v_cvt_pk_bf16_f32 v33, v162, v163
    v_lshlrev_b32 v130, 16, v32
    v_and_b32 v131, 0xffff0000, v32
    v_lshlrev_b32 v162, 16, v33
    v_and_b32 v163, 0xffff0000, v33
    v_pk_mul_f32 v[34:35], v[130:131], v[130:131]
    v_pk_fma_f32 v[34:35], v[34:35], v[40:41], v[42:43]
    v_pk_mul_f32 v[34:35], v[34:35], v[130:131]
    v_exp_f32 v34, v34
    v_exp_f32 v35, v35
    s_nop 0
    v_pk_add_f32 v[34:35], v[34:35], 1.0 op_sel_hi:[1,0]
    v_rcp_f32 v34, v34
    v_rcp_f32 v35, v35
    s_nop 0
    v_pk_mul_f32 v[34:35], v[34:35], v[130:131]
    v_cvt_pk_bf16_f32 v32, v34, v35
    v_lshlrev_b32 v34, 16, v32
    v_and_b32 v35, 0xffff0000, v32
    v_pk_mul_f32 v[34:35], v[34:35], v[162:163]
    v_cvt_pk_bf16_f32 v73, v34, v35
    v_cvt_pk_bf16_f32 v32, v132, v133
    v_cvt_pk_bf16_f32 v33, v164, v165
    v_lshlrev_b32 v132, 16, v32
    v_and_b32 v133, 0xffff0000, v32
    v_lshlrev_b32 v164, 16, v33
    v_and_b32 v165, 0xffff0000, v33
    v_pk_mul_f32 v[34:35], v[132:133], v[132:133]
    v_pk_fma_f32 v[34:35], v[34:35], v[40:41], v[42:43]
    v_pk_mul_f32 v[34:35], v[34:35], v[132:133]
    v_exp_f32 v34, v34
    v_exp_f32 v35, v35
    s_nop 0
    v_pk_add_f32 v[34:35], v[34:35], 1.0 op_sel_hi:[1,0]
    v_rcp_f32 v34, v34
    v_rcp_f32 v35, v35
    s_nop 0
    v_pk_mul_f32 v[34:35], v[34:35], v[132:133]
    v_cvt_pk_bf16_f32 v32, v34, v35
    v_lshlrev_b32 v34, 16, v32
    v_and_b32 v35, 0xffff0000, v32
    v_pk_mul_f32 v[34:35], v[34:35], v[164:165]
    v_cvt_pk_bf16_f32 v74, v34, v35
    v_cvt_pk_bf16_f32 v32, v134, v135
    v_cvt_pk_bf16_f32 v33, v166, v167
    v_lshlrev_b32 v134, 16, v32
    v_and_b32 v135, 0xffff0000, v32
    v_lshlrev_b32 v166, 16, v33
    v_and_b32 v167, 0xffff0000, v33
    v_pk_mul_f32 v[34:35], v[134:135], v[134:135]
    v_pk_fma_f32 v[34:35], v[34:35], v[40:41], v[42:43]
    v_pk_mul_f32 v[34:35], v[34:35], v[134:135]
    v_exp_f32 v34, v34
    v_exp_f32 v35, v35
    s_nop 0
    v_pk_add_f32 v[34:35], v[34:35], 1.0 op_sel_hi:[1,0]
    v_rcp_f32 v34, v34
    v_rcp_f32 v35, v35
    s_nop 0
    v_pk_mul_f32 v[34:35], v[34:35], v[134:135]
    v_cvt_pk_bf16_f32 v32, v34, v35
    v_lshlrev_b32 v34, 16, v32
    v_and_b32 v35, 0xffff0000, v32
    v_pk_mul_f32 v[34:35], v[34:35], v[166:167]
    v_cvt_pk_bf16_f32 v75, v34, v35
    v_cvt_pk_bf16_f32 v32, v136, v137
    v_cvt_pk_bf16_f32 v33, v168, v169
    v_lshlrev_b32 v136, 16, v32
    v_and_b32 v137, 0xffff0000, v32
    v_lshlrev_b32 v168, 16, v33
    v_and_b32 v169, 0xffff0000, v33
    v_pk_mul_f32 v[34:35], v[136:137], v[136:137]
    v_pk_fma_f32 v[34:35], v[34:35], v[40:41], v[42:43]
    v_pk_mul_f32 v[34:35], v[34:35], v[136:137]
    v_exp_f32 v34, v34
    v_exp_f32 v35, v35
    s_nop 0
    v_pk_add_f32 v[34:35], v[34:35], 1.0 op_sel_hi:[1,0]
    v_rcp_f32 v34, v34
    v_rcp_f32 v35, v35
    s_nop 0
    v_pk_mul_f32 v[34:35], v[34:35], v[136:137]
    v_cvt_pk_bf16_f32 v32, v34, v35
    v_lshlrev_b32 v34, 16, v32
    v_and_b32 v35, 0xffff0000, v32
    v_pk_mul_f32 v[34:35], v[34:35], v[168:169]
    v_cvt_pk_bf16_f32 v76, v34, v35
    v_cvt_pk_bf16_f32 v32, v138, v139
    v_cvt_pk_bf16_f32 v33, v170, v171
    v_lshlrev_b32 v138, 16, v32
    v_and_b32 v139, 0xffff0000, v32
    v_lshlrev_b32 v170, 16, v33
    v_and_b32 v171, 0xffff0000, v33
    v_pk_mul_f32 v[34:35], v[138:139], v[138:139]
    v_pk_fma_f32 v[34:35], v[34:35], v[40:41], v[42:43]
    v_pk_mul_f32 v[34:35], v[34:35], v[138:139]
    v_exp_f32 v34, v34
    v_exp_f32 v35, v35
    s_nop 0
    v_pk_add_f32 v[34:35], v[34:35], 1.0 op_sel_hi:[1,0]
    v_rcp_f32 v34, v34
    v_rcp_f32 v35, v35
    s_nop 0
    v_pk_mul_f32 v[34:35], v[34:35], v[138:139]
    v_cvt_pk_bf16_f32 v32, v34, v35
    v_lshlrev_b32 v34, 16, v32
    v_and_b32 v35, 0xffff0000, v32
    v_pk_mul_f32 v[34:35], v[34:35], v[170:171]
    v_cvt_pk_bf16_f32 v77, v34, v35
    v_cvt_pk_bf16_f32 v32, v140, v141
    v_cvt_pk_bf16_f32 v33, v172, v173
    v_lshlrev_b32 v140, 16, v32
    v_and_b32 v141, 0xffff0000, v32
    v_lshlrev_b32 v172, 16, v33
    v_and_b32 v173, 0xffff0000, v33
    v_pk_mul_f32 v[34:35], v[140:141], v[140:141]
    v_pk_fma_f32 v[34:35], v[34:35], v[40:41], v[42:43]
    v_pk_mul_f32 v[34:35], v[34:35], v[140:141]
    v_exp_f32 v34, v34
    v_exp_f32 v35, v35
    s_nop 0
    v_pk_add_f32 v[34:35], v[34:35], 1.0 op_sel_hi:[1,0]
    v_rcp_f32 v34, v34
    v_rcp_f32 v35, v35
    s_nop 0
    v_pk_mul_f32 v[34:35], v[34:35], v[140:141]
    v_cvt_pk_bf16_f32 v32, v34, v35
    v_lshlrev_b32 v34, 16, v32
    v_and_b32 v35, 0xffff0000, v32
    v_pk_mul_f32 v[34:35], v[34:35], v[172:173]
    v_cvt_pk_bf16_f32 v78, v34, v35
    v_cvt_pk_bf16_f32 v32, v142, v143
    v_cvt_pk_bf16_f32 v33, v174, v175
    v_lshlrev_b32 v142, 16, v32
    v_and_b32 v143, 0xffff0000, v32
    v_lshlrev_b32 v174, 16, v33
    v_and_b32 v175, 0xffff0000, v33
    v_pk_mul_f32 v[34:35], v[142:143], v[142:143]
    v_pk_fma_f32 v[34:35], v[34:35], v[40:41], v[42:43]
    v_pk_mul_f32 v[34:35], v[34:35], v[142:143]
    v_exp_f32 v34, v34
    v_exp_f32 v35, v35
    s_nop 0
    v_pk_add_f32 v[34:35], v[34:35], 1.0 op_sel_hi:[1,0]
    v_rcp_f32 v34, v34
    v_rcp_f32 v35, v35
    s_nop 0
    v_pk_mul_f32 v[34:35], v[34:35], v[142:143]
    v_cvt_pk_bf16_f32 v32, v34, v35
    v_lshlrev_b32 v34, 16, v32
    v_and_b32 v35, 0xffff0000, v32
    v_pk_mul_f32 v[34:35], v[34:35], v[174:175]
    v_cvt_pk_bf16_f32 v79, v34, v35
    buffer_store_dwordx4 v[72:75], v5, s[48:51], s15 offen offset:64
    buffer_store_dwordx4 v[76:79], v5, s[48:51], s15 offen offset:80
L_k1_end:
    s_endpgm
.globl k3_kernel
.p2align 8
.type k3_kernel,@function
k3_kernel:
    s_cmp_ge_u32 s2, 224
    s_cbranch_scc1 L_k3_end
    s_load_dwordx16 s[16:31], s[0:1], 0
    s_load_dwordx4 s[32:35], s[0:1], 64
    v_lshrrev_b32 v1, 6, v0
    v_and_b32 v2, 63, v0
    v_readfirstlane_b32 s3, v1
    s_and_b32 s4, s2, 7
    s_lshr_b32 s5, s2, 3
    s_and_b32 s6, s5, 3
    s_lshl_b32 s4, s4, 2
    s_add_u32 s4, s4, s6
    s_lshr_b32 s5, s5, 2
    s_lshl_b32 s10, s5, 7
    s_cmp_lt_u32 s3, 4
    s_cbranch_scc1 L_k3_cons
    s_sub_u32 s3, s3, 4
    v_subrev_u32 v1, 4, v1
    v_lshrrev_b32 v3, 3, v2
    v_lshl_add_u32 v3, v1, 4, v3
    v_and_b32 v4, 7, v2
    v_bfe_u32 v5, v2, 4, 1
    v_lshlrev_b32 v5, 2, v5
    v_xor_b32 v5, v4, v5
    v_mul_u32_u24 v6, 896, v3
    v_lshl_add_u32 v6, v5, 4, v6
    v_add_u32 v7, 7168, v6
    v_mul_u32_u24 v8, 4224, v3
    v_lshl_add_u32 v8, v5, 4, v8
    v_add_u32 v9, 33792, v8
    v_lshrrev_b32 v10, 4, v2
    v_xor_b32 v11, v4, v10
    v_mul_u32_u24 v12, 3712, v3
    v_lshl_add_u32 v10, v11, 4, v12
    v_xor_b32 v11, 4, v11
    v_lshl_add_u32 v11, v11, 4, v12
    v_add_u32 v11, 29696, v11
    s_mul_i32 s11, s4, 237568
    s_lshl_b32 s12, s4, 7
    s_lshl_b32 s13, s3, 11
    s_waitcnt lgkmcnt(0)
    s_mov_b32 s40, s28
    s_mov_b32 s41, s29
    s_mov_b32 s42, 0x188000
    s_mov_b32 s43, 0x00020000
    s_add_u32 s44, s34, 0x800000
    s_addc_u32 s45, s35, 0
    s_mov_b32 s46, 0x740000
    s_mov_b32 s47, 0x00020000
    s_add_u32 s48, s34, 0x440000
    s_addc_u32 s49, s35, 0
    s_mov_b32 s50, 0x1ce000
    s_mov_b32 s51, 0x00020000
    s_add_u32 s52, s34, 0x600000
    s_addc_u32 s53, s35, 0
    s_mov_b32 s54, 0x62000
    s_mov_b32 s55, 0x00020000
    s_add_u32 s14, s10, 0
    s_add_u32 s15, s11, 0
    s_add_u32 s60, s13, 0
    s_mov_b32 m0, s60
    s_add_u32 s60, s60, 8192
    buffer_load_dwordx4 v6, s[40:43], s14 offen lds
    s_mov_b32 m0, s60
    s_nop 0
    buffer_load_dwordx4 v10, s[44:47], s15 offen lds
    s_add_u32 s60, s13, 1024
    s_mov_b32 m0, s60
    s_add_u32 s60, s60, 8192
    buffer_load_dwordx4 v7, s[40:43], s14 offen lds
    s_mov_b32 m0, s60
    s_nop 0
    buffer_load_dwordx4 v11, s[44:47], s15 offen lds
    s_add_u32 s14, s10, 57344
    s_add_u32 s15, s11, 128
    s_add_u32 s60, s13, 16384
    s_mov_b32 m0, s60
    s_add_u32 s60, s60, 8192
    buffer_load_dwordx4 v6, s[40:43], s14 offen lds
    s_mov_b32 m0, s60
    s_nop 0
    buffer_load_dwordx4 v10, s[44:47], s15 offen lds
    s_add_u32 s60, s13, 17408
    s_mov_b32 m0, s60
    s_add_u32 s60, s60, 8192
    buffer_load_dwordx4 v7, s[40:43], s14 offen lds
    s_mov_b32 m0, s60
    s_nop 0
    buffer_load_dwordx4 v11, s[44:47], s15 offen lds
    s_add_u32 s14, s10, 114688
    s_add_u32 s15, s11, 256
    s_add_u32 s60, s13, 32768
    s_mov_b32 m0, s60
    s_add_u32 s60, s60, 8192
    buffer_load_dwordx4 v6, s[40:43], s14 offen lds
    s_mov_b32 m0, s60
    s_nop 0
    buffer_load_dwordx4 v10, s[44:47], s15 offen lds
    s_add_u32 s60, s13, 33792
    s_mov_b32 m0, s60
    s_add_u32 s60, s60, 8192
    buffer_load_dwordx4 v7, s[40:43], s14 offen lds
    s_mov_b32 m0, s60
    s_nop 0
    buffer_load_dwordx4 v11, s[44:47], s15 offen lds
    s_add_u32 s14, s10, 172032
    s_add_u32 s15, s11, 384
    s_add_u32 s60, s13, 49152
    s_mov_b32 m0, s60
    s_add_u32 s60, s60, 8192
    buffer_load_dwordx4 v6, s[40:43], s14 offen lds
    s_mov_b32 m0, s60
    s_nop 0
    buffer_load_dwordx4 v10, s[44:47], s15 offen lds
    s_add_u32 s60, s13, 50176
    s_mov_b32 m0, s60
    s_add_u32 s60, s60, 8192
    buffer_load_dwordx4 v7, s[40:43], s14 offen lds
    s_mov_b32 m0, s60
    s_nop 0
    buffer_load_dwordx4 v11, s[44:47], s15 offen lds
    s_add_u32 s14, s10, 229376
    s_add_u32 s15, s11, 512
    s_add_u32 s60, s13, 65536
    s_mov_b32 m0, s60
    s_add_u32 s60, s60, 8192
    buffer_load_dwordx4 v6, s[40:43], s14 offen lds
    s_mov_b32 m0, s60
    s_nop 0
    buffer_load_dwordx4 v10, s[44:47], s15 offen lds
    s_add_u32 s60, s13, 66560
    s_mov_b32 m0, s60
    s_add_u32 s60, s60, 8192
    buffer_load_dwordx4 v7, s[40:43], s14 offen lds
    s_mov_b32 m0, s60
    s_nop 0
    buffer_load_dwordx4 v11, s[44:47], s15 offen lds
    s_waitcnt vmcnt(16)
    s_barrier
    s_add_u32 s14, s10, 286720
    s_add_u32 s15, s11, 640
    s_add_u32 s60, s13, 81920
    s_mov_b32 m0, s60
    s_add_u32 s60, s60, 8192
    buffer_load_dwordx4 v6, s[40:43], s14 offen lds
    s_mov_b32 m0, s60
    s_nop 0
    buffer_load_dwordx4 v10, s[44:47], s15 offen lds
    s_add_u32 s60, s13, 82944
    s_mov_b32 m0, s60
    s_add_u32 s60, s60, 8192
    buffer_load_dwordx4 v7, s[40:43], s14 offen lds
    s_mov_b32 m0, s60
    s_nop 0
    buffer_load_dwordx4 v11, s[44:47], s15 offen lds
    s_waitcnt vmcnt(16)
    s_barrier
    s_add_u32 s14, s10, 344064
    s_add_u32 s15, s11, 768
    s_add_u32 s60, s13, 98304
    s_mov_b32 m0, s60
    s_add_u32 s60, s60, 8192
    buffer_load_dwordx4 v6, s[40:43], s14 offen lds
    s_mov_b32 m0, s60
    s_nop 0
    buffer_load_dwordx4 v10, s[44:47], s15 offen lds
    s_add_u32 s60, s13, 99328
    s_mov_b32 m0, s60
    s_add_u32 s60, s60, 8192
    buffer_load_dwordx4 v7, s[40:43], s14 offen lds
    s_mov_b32 m0, s60
    s_nop 0
    buffer_load_dwordx4 v11, s[44:47], s15 offen lds
    s_waitcnt vmcnt(16)
    s_barrier
    s_add_u32 s14, s10, 401408
    s_add_u32 s15, s11, 896
    s_add_u32 s60, s13, 0
    s_mov_b32 m0, s60
    s_add_u32 s60, s60, 8192
    buffer_load_dwordx4 v6, s[40:43], s14 offen lds
    s_mov_b32 m0, s60
    s_nop 0
    buffer_load_dwordx4 v10, s[44:47], s15 offen lds
    s_add_u32 s60, s13, 1024
    s_mov_b32 m0, s60
    s_add_u32 s60, s60, 8192
    buffer_load_dwordx4 v7, s[40:43], s14 offen lds
    s_mov_b32 m0, s60
    s_nop 0
    buffer_load_dwordx4 v11, s[44:47], s15 offen lds
    s_waitcnt vmcnt(16)
    s_barrier
    s_add_u32 s14, s10, 458752
    s_add_u32 s15, s11, 1024
    s_add_u32 s60, s13, 16384
    s_mov_b32 m0, s60
    s_add_u32 s60, s60, 8192
    buffer_load_dwordx4 v6, s[40:43], s14 offen lds
    s_mov_b32 m0, s60
    s_nop 0
    buffer_load_dwordx4 v10, s[44:47], s15 offen lds
    s_add_u32 s60, s13, 17408
    s_mov_b32 m0, s60
    s_add_u32 s60, s60, 8192
    buffer_load_dwordx4 v7, s[40:43], s14 offen lds
    s_mov_b32 m0, s60
    s_nop 0
    buffer_load_dwordx4 v11, s[44:47], s15 offen lds
    s_waitcnt vmcnt(16)
    s_barrier
    s_add_u32 s14, s10, 516096
    s_add_u32 s15, s11, 1152
    s_add_u32 s60, s13, 32768
    s_mov_b32 m0, s60
    s_add_u32 s60, s60, 8192
    buffer_load_dwordx4 v6, s[40:43], s14 offen lds
    s_mov_b32 m0, s60
    s_nop 0
    buffer_load_dwordx4 v10, s[44:47], s15 offen lds
    s_add_u32 s60, s13, 33792
    s_mov_b32 m0, s60
    s_add_u32 s60, s60, 8192
    buffer_load_dwordx4 v7, s[40:43], s14 offen lds
    s_mov_b32 m0, s60
    s_nop 0
    buffer_load_dwordx4 v11, s[44:47], s15 offen lds
    s_waitcnt vmcnt(16)
    s_barrier
    s_add_u32 s14, s10, 573440
    s_add_u32 s15, s11, 1280
    s_add_u32 s60, s13, 49152
    s_mov_b32 m0, s60
    s_add_u32 s60, s60, 8192
    buffer_load_dwordx4 v6, s[40:43], s14 offen lds
    s_mov_b32 m0, s60
    s_nop 0
    buffer_load_dwordx4 v10, s[44:47], s15 offen lds
    s_add_u32 s60, s13, 50176
    s_mov_b32 m0, s60
    s_add_u32 s60, s60, 8192
    buffer_load_dwordx4 v7, s[40:43], s14 offen lds
    s_mov_b32 m0, s60
    s_nop 0
    buffer_load_dwordx4 v11, s[44:47], s15 offen lds
    s_waitcnt vmcnt(16)
    s_barrier
    s_add_u32 s14, s10, 630784
    s_add_u32 s15, s11, 1408
    s_add_u32 s60, s13, 65536
    s_mov_b32 m0, s60
    s_add_u32 s60, s60, 8192
    buffer_load_dwordx4 v6, s[40:43], s14 offen lds
    s_mov_b32 m0, s60
    s_nop 0
    buffer_load_dwordx4 v10, s[44:47], s15 offen lds
    s_add_u32 s60, s13, 66560
    s_mov_b32 m0, s60
    s_add_u32 s60, s60, 8192
    buffer_load_dwordx4 v7, s[40:43], s14 offen lds
    s_mov_b32 m0, s60
    s_nop 0
    buffer_load_dwordx4 v11, s[44:47], s15 offen lds
    s_waitcnt vmcnt(16)
    s_barrier
    s_add_u32 s14, s10, 688128
    s_add_u32 s15, s11, 1536
    s_add_u32 s60, s13, 81920
    s_mov_b32 m0, s60
    s_add_u32 s60, s60, 8192
    buffer_load_dwordx4 v6, s[40:43], s14 offen lds
    s_mov_b32 m0, s60
    s_nop 0
    buffer_load_dwordx4 v10, s[44:47], s15 offen lds
    s_add_u32 s60, s13, 82944
    s_mov_b32 m0, s60
    s_add_u32 s60, s60, 8192
    buffer_load_dwordx4 v7, s[40:43], s14 offen lds
    s_mov_b32 m0, s60
    s_nop 0
    buffer_load_dwordx4 v11, s[44:47], s15 offen lds
    s_waitcnt vmcnt(16)
    s_barrier
    s_add_u32 s14, s10, 745472
    s_add_u32 s15, s11, 1664
    s_add_u32 s60, s13, 98304
    s_mov_b32 m0, s60
    s_add_u32 s60, s60, 8192
    buffer_load_dwordx4 v6, s[40:43], s14 offen lds
    s_mov_b32 m0, s60
    s_nop 0
    buffer_load_dwordx4 v10, s[44:47], s15 offen lds
    s_add_u32 s60, s13, 99328
    s_mov_b32 m0, s60
    s_add_u32 s60, s60, 8192
    buffer_load_dwordx4 v7, s[40:43], s14 offen lds
    s_mov_b32 m0, s60
    s_nop 0
    buffer_load_dwordx4 v11, s[44:47], s15 offen lds
    s_waitcnt vmcnt(16)
    s_barrier
    s_add_u32 s14, s10, 802816
    s_add_u32 s15, s11, 1792
    s_add_u32 s60, s13, 0
    s_mov_b32 m0, s60
    s_add_u32 s60, s60, 8192
    buffer_load_dwordx4 v6, s[40:43], s14 offen lds
    s_mov_b32 m0, s60
    s_nop 0
    buffer_load_dwordx4 v10, s[44:47], s15 offen lds
    s_add_u32 s60, s13, 1024
    s_mov_b32 m0, s60
    s_add_u32 s60, s60, 8192
    buffer_load_dwordx4 v7, s[40:43], s14 offen lds
    s_mov_b32 m0, s60
    s_nop 0
    buffer_load_dwordx4 v11, s[44:47], s15 offen lds
    s_waitcnt vmcnt(16)
    s_barrier
    s_add_u32 s14, s10, 860160
    s_add_u32 s15, s11, 1920
    s_add_u32 s60, s13, 16384
    s_mov_b32 m0, s60
    s_add_u32 s60, s60, 8192
    buffer_load_dwordx4 v6, s[40:43], s14 offen lds
    s_mov_b32 m0, s60
    s_nop 0
    buffer_load_dwordx4 v10, s[44:47], s15 offen lds
    s_add_u32 s60, s13, 17408
    s_mov_b32 m0, s60
    s_add_u32 s60, s60, 8192
    buffer_load_dwordx4 v7, s[40:43], s14 offen lds
    s_mov_b32 m0, s60
    s_nop 0
    buffer_load_dwordx4 v11, s[44:47], s15 offen lds
    s_waitcnt vmcnt(16)
    s_barrier
    s_add_u32 s14, s10, 917504
    s_add_u32 s15, s11, 2048
    s_add_u32 s60, s13, 32768
    s_mov_b32 m0, s60
    s_add_u32 s60, s60, 8192
    buffer_load_dwordx4 v6, s[40:43], s14 offen lds
    s_mov_b32 m0, s60
    s_nop 0
    buffer_load_dwordx4 v10, s[44:47], s15 offen lds
    s_add_u32 s60, s13, 33792
    s_mov_b32 m0, s60
    s_add_u32 s60, s60, 8192
    buffer_load_dwordx4 v7, s[40:43], s14 offen lds
    s_mov_b32 m0, s60
    s_nop 0
    buffer_load_dwordx4 v11, s[44:47], s15 offen lds
    s_waitcnt vmcnt(16)
    s_barrier
    s_add_u32 s14, s10, 974848
    s_add_u32 s15, s11, 2176
    s_add_u32 s60, s13, 49152
    s_mov_b32 m0, s60
    s_add_u32 s60, s60, 8192
    buffer_load_dwordx4 v6, s[40:43], s14 offen lds
    s_mov_b32 m0, s60
    s_nop 0
    buffer_load_dwordx4 v10, s[44:47], s15 offen lds
    s_add_u32 s60, s13, 50176
    s_mov_b32 m0, s60
    s_add_u32 s60, s60, 8192
    buffer_load_dwordx4 v7, s[40:43], s14 offen lds
    s_mov_b32 m0, s60
    s_nop 0
    buffer_load_dwordx4 v11, s[44:47], s15 offen lds
    s_waitcnt vmcnt(16)
    s_barrier
    s_add_u32 s14, s10, 1032192
    s_add_u32 s15, s11, 2304
    s_add_u32 s60, s13, 65536
    s_mov_b32 m0, s60
    s_add_u32 s60, s60, 8192
    buffer_load_dwordx4 v6, s[40:43], s14 offen lds
    s_mov_b32 m0, s60
    s_nop 0
    buffer_load_dwordx4 v10, s[44:47], s15 offen lds
    s_add_u32 s60, s13, 66560
    s_mov_b32 m0, s60
    s_add_u32 s60, s60, 8192
    buffer_load_dwordx4 v7, s[40:43], s14 offen lds
    s_mov_b32 m0, s60
    s_nop 0
    buffer_load_dwordx4 v11, s[44:47], s15 offen lds
    s_waitcnt vmcnt(16)
    s_barrier
    s_add_u32 s14, s10, 1089536
    s_add_u32 s15, s11, 2432
    s_add_u32 s60, s13, 81920
    s_mov_b32 m0, s60
    s_add_u32 s60, s60, 8192
    buffer_load_dwordx4 v6, s[40:43], s14 offen lds
    s_mov_b32 m0, s60
    s_nop 0
    buffer_load_dwordx4 v10, s[44:47], s15 offen lds
    s_add_u32 s60, s13, 82944
    s_mov_b32 m0, s60
    s_add_u32 s60, s60, 8192
    buffer_load_dwordx4 v7, s[40:43], s14 offen lds
    s_mov_b32 m0, s60
    s_nop 0
    buffer_load_dwordx4 v11, s[44:47], s15 offen lds
    s_waitcnt vmcnt(16)
    s_barrier
    s_add_u32 s14, s10, 1146880
    s_add_u32 s15, s11, 2560
    s_add_u32 s60, s13, 98304
    s_mov_b32 m0, s60
    s_add_u32 s60, s60, 8192
    buffer_load_dwordx4 v6, s[40:43], s14 offen lds
    s_mov_b32 m0, s60
    s_nop 0
    buffer_load_dwordx4 v10, s[44:47], s15 offen lds
    s_add_u32 s60, s13, 99328
    s_mov_b32 m0, s60
    s_add_u32 s60, s60, 8192
    buffer_load_dwordx4 v7, s[40:43], s14 offen lds
    s_mov_b32 m0, s60
    s_nop 0
    buffer_load_dwordx4 v11, s[44:47], s15 offen lds
    s_waitcnt vmcnt(16)
    s_barrier
    s_add_u32 s14, s10, 1204224
    s_add_u32 s15, s11, 2688
    s_add_u32 s60, s13, 0
    s_mov_b32 m0, s60
    s_add_u32 s60, s60, 8192
    buffer_load_dwordx4 v6, s[40:43], s14 offen lds
    s_mov_b32 m0, s60
    s_nop 0
    buffer_load_dwordx4 v10, s[44:47], s15 offen lds
    s_add_u32 s60, s13, 1024
    s_mov_b32 m0, s60
    s_add_u32 s60, s60, 8192
    buffer_load_dwordx4 v7, s[40:43], s14 offen lds
    s_mov_b32 m0, s60
    s_nop 0
    buffer_load_dwordx4 v11, s[44:47], s15 offen lds
    s_waitcnt vmcnt(16)
    s_barrier
    s_add_u32 s14, s10, 1261568
    s_add_u32 s15, s11, 2816
    s_add_u32 s60, s13, 16384
    s_mov_b32 m0, s60
    s_add_u32 s60, s60, 8192
    buffer_load_dwordx4 v6, s[40:43], s14 offen lds
    s_mov_b32 m0, s60
    s_nop 0
    buffer_load_dwordx4 v10, s[44:47], s15 offen lds
    s_add_u32 s60, s13, 17408
    s_mov_b32 m0, s60
    s_add_u32 s60, s60, 8192
    buffer_load_dwordx4 v7, s[40:43], s14 offen lds
    s_mov_b32 m0, s60
    s_nop 0
    buffer_load_dwordx4 v11, s[44:47], s15 offen lds
    s_waitcnt vmcnt(16)
    s_barrier
    s_add_u32 s14, s10, 1318912
    s_add_u32 s15, s11, 2944
    s_add_u32 s60, s13, 32768
    s_mov_b32 m0, s60
    s_add_u32 s60, s60, 8192
    buffer_load_dwordx4 v6, s[40:43], s14 offen lds
    s_mov_b32 m0, s60
    s_nop 0
    buffer_load_dwordx4 v10, s[44:47], s15 offen lds
    s_add_u32 s60, s13, 33792
    s_mov_b32 m0, s60
    s_add_u32 s60, s60, 8192
    buffer_load_dwordx4 v7, s[40:43], s14 offen lds
    s_mov_b32 m0, s60
    s_nop 0
    buffer_load_dwordx4 v11, s[44:47], s15 offen lds
    s_waitcnt vmcnt(16)
    s_barrier
    s_add_u32 s14, s10, 1376256
    s_add_u32 s15, s11, 3072
    s_add_u32 s60, s13, 49152
    s_mov_b32 m0, s60
    s_add_u32 s60, s60, 8192
    buffer_load_dwordx4 v6, s[40:43], s14 offen lds
    s_mov_b32 m0, s60
    s_nop 0
    buffer_load_dwordx4 v10, s[44:47], s15 offen lds
    s_add_u32 s60, s13, 50176
    s_mov_b32 m0, s60
    s_add_u32 s60, s60, 8192
    buffer_load_dwordx4 v7, s[40:43], s14 offen lds
    s_mov_b32 m0, s60
    s_nop 0
    buffer_load_dwordx4 v11, s[44:47], s15 offen lds
    s_waitcnt vmcnt(16)
    s_barrier
    s_add_u32 s14, s10, 1433600
    s_add_u32 s15, s11, 3200
    s_add_u32 s60, s13, 65536
    s_mov_b32 m0, s60
    s_add_u32 s60, s60, 8192
    buffer_load_dwordx4 v6, s[40:43], s14 offen lds
    s_mov_b32 m0, s60
    s_nop 0
    buffer_load_dwordx4 v10, s[44:47], s15 offen lds
    s_add_u32 s60, s13, 66560
    s_mov_b32 m0, s60
    s_add_u32 s60, s60, 8192
    buffer_load_dwordx4 v7, s[40:43], s14 offen lds
    s_mov_b32 m0, s60
    s_nop 0
    buffer_load_dwordx4 v11, s[44:47], s15 offen lds
    s_waitcnt vmcnt(16)
    s_barrier
    s_add_u32 s14, s10, 1490944
    s_add_u32 s15, s11, 3328
    s_add_u32 s60, s13, 81920
    s_mov_b32 m0, s60
    s_add_u32 s60, s60, 8192
    buffer_load_dwordx4 v6, s[40:43], s14 offen lds
    s_mov_b32 m0, s60
    s_nop 0
    buffer_load_dwordx4 v10, s[44:47], s15 offen lds
    s_add_u32 s60, s13, 82944
    s_mov_b32 m0, s60
    s_add_u32 s60, s60, 8192
    buffer_load_dwordx4 v7, s[40:43], s14 offen lds
    s_mov_b32 m0, s60
    s_nop 0
    buffer_load_dwordx4 v11, s[44:47], s15 offen lds
    s_waitcnt vmcnt(16)
    s_barrier
    s_add_u32 s14, s10, 1548288
    s_add_u32 s15, s11, 3456
    s_add_u32 s60, s13, 98304
    s_mov_b32 m0, s60
    s_add_u32 s60, s60, 8192
    buffer_load_dwordx4 v6, s[40:43], s14 offen lds
    s_mov_b32 m0, s60
    s_nop 0
    buffer_load_dwordx4 v10, s[44:47], s15 offen lds
    s_add_u32 s60, s13, 99328
    s_mov_b32 m0, s60
    s_add_u32 s60, s60, 8192
    buffer_load_dwordx4 v7, s[40:43], s14 offen lds
    s_mov_b32 m0, s60
    s_nop 0
    buffer_load_dwordx4 v11, s[44:47], s15 offen lds
    s_waitcnt vmcnt(16)
    s_barrier
    s_add_u32 s14, s10, 0
    s_add_u32 s15, s12, 0
    s_add_u32 s60, s13, 0
    s_add_u32 s60, s60, 8192
    s_mov_b32 m0, s60
    s_nop 0
    buffer_load_dwordx4 v8, s[48:51], s15 offen lds
    s_add_u32 s60, s13, 1024
    s_add_u32 s60, s60, 8192
    s_mov_b32 m0, s60
    s_nop 0
    buffer_load_dwordx4 v9, s[48:51], s15 offen lds
    s_waitcnt vmcnt(14)
    s_barrier
    s_add_u32 s14, s10, 57344
    s_add_u32 s15, s12, 270336
    s_add_u32 s60, s13, 16384
    s_add_u32 s60, s60, 8192
    s_mov_b32 m0, s60
    s_nop 0
    buffer_load_dwordx4 v8, s[48:51], s15 offen lds
    s_add_u32 s60, s13, 17408
    s_add_u32 s60, s60, 8192
    s_mov_b32 m0, s60
    s_nop 0
    buffer_load_dwordx4 v9, s[48:51], s15 offen lds
    s_waitcnt vmcnt(12)
    s_barrier
    s_add_u32 s14, s10, 114688
    s_add_u32 s15, s12, 540672
    s_add_u32 s60, s13, 32768
    s_add_u32 s60, s60, 8192
    s_mov_b32 m0, s60
    s_nop 0
    buffer_load_dwordx4 v8, s[48:51], s15 offen lds
    s_add_u32 s60, s13, 33792
    s_add_u32 s60, s60, 8192
    s_mov_b32 m0, s60
    s_nop 0
    buffer_load_dwordx4 v9, s[48:51], s15 offen lds
    s_waitcnt vmcnt(10)
    s_barrier
    s_add_u32 s14, s10, 172032
    s_add_u32 s15, s12, 811008
    s_add_u32 s60, s13, 49152
    s_add_u32 s60, s60, 8192
    s_mov_b32 m0, s60
    s_nop 0
    buffer_load_dwordx4 v8, s[48:51], s15 offen lds
    s_add_u32 s60, s13, 50176
    s_add_u32 s60, s60, 8192
    s_mov_b32 m0, s60
    s_nop 0
    buffer_load_dwordx4 v9, s[48:51], s15 offen lds
    s_waitcnt vmcnt(8)
    s_barrier
    s_add_u32 s14, s10, 229376
    s_add_u32 s15, s12, 1081344
    s_add_u32 s60, s13, 65536
    s_add_u32 s60, s60, 8192
    s_mov_b32 m0, s60
    s_nop 0
    buffer_load_dwordx4 v8, s[48:51], s15 offen lds
    s_add_u32 s60, s13, 66560
    s_add_u32 s60, s60, 8192
    s_mov_b32 m0, s60
    s_nop 0
    buffer_load_dwordx4 v9, s[48:51], s15 offen lds
    s_waitcnt vmcnt(8)
    s_barrier
    s_add_u32 s14, s10, 286720
    s_add_u32 s15, s12, 1351680
    s_add_u32 s60, s13, 81920
    s_add_u32 s60, s60, 8192
    s_mov_b32 m0, s60
    s_nop 0
    buffer_load_dwordx4 v8, s[48:51], s15 offen lds
    s_add_u32 s60, s13, 82944
    s_add_u32 s60, s60, 8192
    s_mov_b32 m0, s60
    s_nop 0
    buffer_load_dwordx4 v9, s[48:51], s15 offen lds
    s_waitcnt vmcnt(8)
    s_barrier
    s_add_u32 s14, s10, 344064
    s_add_u32 s15, s12, 1622016
    s_add_u32 s60, s13, 98304
    s_add_u32 s60, s60, 8192
    s_mov_b32 m0, s60
    s_nop 0
    buffer_load_dwordx4 v8, s[48:51], s15 offen lds
    s_add_u32 s60, s13, 99328
    s_add_u32 s60, s60, 8192
    s_mov_b32 m0, s60
    s_nop 0
    buffer_load_dwordx4 v9, s[48:51], s15 offen lds
    s_waitcnt vmcnt(8)
    s_barrier
    s_waitcnt vmcnt(6)
    s_barrier
    s_waitcnt vmcnt(4)
    s_barrier
    s_waitcnt vmcnt(2)
    s_barrier
    s_waitcnt vmcnt(0)
    s_barrier
    s_endpgm
L_k3_cons:
    s_lshr_b32 s6, s3, 1
    s_and_b32 s7, s3, 1
    v_and_b32 v12, 31, v2
    s_lshl_b32 s8, s6, 5
    v_add_u32 v12, s8, v12
    v_lshrrev_b32 v13, 5, v2
    v_mul_u32_u24 v14, 896, v12
    v_lshl_add_u32 v14, v13, 5, v14
    s_lshl_b32 s8, s7, 6
    v_add_u32 v14, s8, v14
    s_mul_i32 s9, s4, 57344
    s_add_u32 s9, s9, s10
    s_waitcnt lgkmcnt(0)
    s_mov_b32 s36, s16
    s_mov_b32 s37, s17
    s_mov_b32 s38, 0x1c0000
    s_mov_b32 s39, 0x00020000
    s_mov_b32 s56, s30
    s_mov_b32 s57, s31
    s_mov_b32 s58, 0x1c0000
    s_mov_b32 s59, 0x00020000
    buffer_load_dwordx4 v[24:27], v14, s[36:39], s9 offen
    buffer_load_dwordx4 v[28:31], v14, s[36:39], s9 offen offset:16
    v_lshrrev_b32 v3, 4, v2
    v_and_b32 v4, 15, v2
    v_lshrrev_b32 v5, 2, v4
    v_and_b32 v4, 3, v4
    v_lshrrev_b32 v15, 1, v3
    v_lshl_add_u32 v15, v15, 3, v5
    v_lshlrev_b32 v15, 7, v15
    v_lshrrev_b32 v16, 1, v5
    v_lshlrev_b32 v16, 2, v16
    v_and_b32 v17, 1, v4
    v_lshlrev_b32 v17, 1, v17
    v_and_b32 v18, 1, v3
    v_add_u32 v17, v17, v18
    s_lshl_b32 s8, s7, 2
    v_add_u32 v17, s8, v17
    v_xor_b32 v17, v17, v16
    v_lshl_add_u32 v17, v17, 4, v15
    v_lshrrev_b32 v18, 1, v4
    v_lshl_add_u32 v17, v18, 3, v17
    v_and_b32 v18, 1, v3
    v_lshlrev_b32 v18, 1, v18
    v_lshrrev_b32 v19, 1, v4
    v_add_u32 v18, v18, v19
    s_lshl_b32 s8, s6, 2
    v_add_u32 v18, s8, v18
    v_xor_b32 v18, v18, v16
    v_lshl_add_u32 v18, v18, 4, v15
    v_and_b32 v19, 1, v4
    v_lshl_add_u32 v18, v19, 3, v18
    v_add_u32 v18, 8192, v18
    v_bfe_u32 v19, v12, 1, 3
    v_add_u32 v20, 0, v13
    v_xor_b32 v20, v20, v19
    v_lshlrev_b32 v20, 4, v20
    v_lshl_add_u32 v20, v12, 7, v20
    v_add_u32 v20, 8192, v20
    v_add_u32 v21, 2, v13
    v_xor_b32 v21, v21, v19
    v_lshlrev_b32 v21, 4, v21
    v_lshl_add_u32 v21, v12, 7, v21
    v_add_u32 v21, 8192, v21
    v_add_u32 v22, 4, v13
    v_xor_b32 v22, v22, v19
    v_lshlrev_b32 v22, 4, v22
    v_lshl_add_u32 v22, v12, 7, v22
    v_add_u32 v22, 8192, v22
    v_add_u32 v23, 6, v13
    v_xor_b32 v23, v23, v19
    v_lshlrev_b32 v23, 4, v23
    v_lshl_add_u32 v23, v12, 7, v23
    v_add_u32 v23, 8192, v23
    v_add_u32 v48, 0x10000, v17
    v_add_u32 v49, 0x10000, v18
    v_add_u32 v50, 0x10000, v20
    v_add_u32 v51, 0x10000, v21
    v_add_u32 v52, 0x10000, v22
    v_add_u32 v53, 0x10000, v23
    v_and_b32 v4, 15, v2
    v_bfe_u32 v5, v4, 2, 1
    v_lshlrev_b32 v5, 4, v5
    v_and_b32 v15, 1, v3
    v_lshl_add_u32 v5, v15, 3, v5
    v_lshrrev_b32 v15, 3, v4
    v_lshl_add_u32 v5, v15, 2, v5
    v_and_b32 v15, 3, v4
    v_add_u32 v5, v5, v15
    s_lshl_b32 s8, s7, 5
    s_lshl_b32 s11, s5, 6
    s_add_u32 s8, s8, s11
    v_add_u32 v5, s8, v5
    v_lshlrev_b32 v15, 2, v13
    s_mov_b32 s11, 0x3b124925
    s_mov_b32 s12, 0x36124925
    v_add_u32 v56, 0, v15
    v_mul_u32_u24 v56, v56, v5
    v_lshrrev_b32 v57, 6, v56
    v_mul_u32_u24 v57, 9363, v57
    v_lshrrev_b32 v57, 16, v57
    v_mul_u32_u24 v57, 448, v57
    v_sub_u32 v58, v56, v57
    v_cvt_f32_u32 v58, v58
    v_mul_f32 v58, s11, v58
    v_cos_f32 v212, v58
    v_sin_f32 v216, v58
    v_add_u32 v56, 1, v15
    v_mul_u32_u24 v56, v56, v5
    v_lshrrev_b32 v57, 6, v56
    v_mul_u32_u24 v57, 9363, v57
    v_lshrrev_b32 v57, 16, v57
    v_mul_u32_u24 v57, 448, v57
    v_sub_u32 v58, v56, v57
    v_cvt_f32_u32 v58, v58
    v_mul_f32 v58, s11, v58
    v_cos_f32 v213, v58
    v_sin_f32 v217, v58
    v_add_u32 v56, 2, v15
    v_mul_u32_u24 v56, v56, v5
    v_lshrrev_b32 v57, 6, v56
    v_mul_u32_u24 v57, 9363, v57
    v_lshrrev_b32 v57, 16, v57
    v_mul_u32_u24 v57, 448, v57
    v_sub_u32 v58, v56, v57
    v_cvt_f32_u32 v58, v58
    v_mul_f32 v58, s11, v58
    v_cos_f32 v214, v58
    v_sin_f32 v218, v58
    v_add_u32 v56, 3, v15
    v_mul_u32_u24 v56, v56, v5
    v_lshrrev_b32 v57, 6, v56
    v_mul_u32_u24 v57, 9363, v57
    v_lshrrev_b32 v57, 16, v57
    v_mul_u32_u24 v57, 448, v57
    v_sub_u32 v58, v56, v57
    v_cvt_f32_u32 v58, v58
    v_mul_f32 v58, s11, v58
    v_cos_f32 v215, v58
    v_sin_f32 v219, v58
    v_lshlrev_b32 v56, 3, v5
    v_lshrrev_b32 v57, 6, v56
    v_mul_u32_u24 v57, 9363, v57
    v_lshrrev_b32 v57, 16, v57
    v_mul_u32_u24 v57, 448, v57
    v_sub_u32 v58, v56, v57
    v_cvt_f32_u32 v58, v58
    v_mul_f32 v58, s11, v58
    v_cos_f32 v228, v58
    v_sin_f32 v229, v58
    s_nop 0
    v_mul_f32 v212, s12, v212
    v_mul_f32 v216, s12, v216
    v_mul_f32 v213, s12, v213
    v_mul_f32 v217, s12, v217
    v_mul_f32 v214, s12, v214
    v_mul_f32 v218, s12, v218
    v_mul_f32 v215, s12, v215
    v_mul_f32 v219, s12, v219
    v_and_b32 v56, 1, v5
    v_lshlrev_b32 v56, 31, v56
    v_mov_b32 v57, 0x35924925
    v_xor_b32 v56, v56, v57
    v_cvt_pk_bf16_f32 v230, v57, v56
    v_cmp_eq_u32 vcc, 0, v13
    v_mov_b32 v64, 0
    v_mov_b32 v65, 0
    v_mov_b32 v66, 0
    v_mov_b32 v67, 0
    v_mov_b32 v68, 0
    v_mov_b32 v69, 0
    v_mov_b32 v70, 0
    v_mov_b32 v71, 0
    v_mov_b32 v72, 0
    v_mov_b32 v73, 0
    v_mov_b32 v74, 0
    v_mov_b32 v75, 0
    v_mov_b32 v76, 0
    v_mov_b32 v77, 0
    v_mov_b32 v78, 0
    v_mov_b32 v79, 0
    v_mov_b32 v80, 0
    v_mov_b32 v81, 0
    v_mov_b32 v82, 0
    v_mov_b32 v83, 0
    v_mov_b32 v84, 0
    v_mov_b32 v85, 0
    v_mov_b32 v86, 0
    v_mov_b32 v87, 0
    v_mov_b32 v88, 0
    v_mov_b32 v89, 0
    v_mov_b32 v90, 0
    v_mov_b32 v91, 0
    v_mov_b32 v92, 0
    v_mov_b32 v93, 0
    v_mov_b32 v94, 0
    v_mov_b32 v95, 0
    s_barrier
    ds_read_b64_tr_b16 v[32:33], v17 offset:0
    ds_read_b64_tr_b16 v[34:35], v17 offset:512
    ds_read_b128 v[36:39], v20 offset:0
    ds_read_b64_tr_b16 v[40:41], v17 offset:2048
    ds_read_b64_tr_b16 v[42:43], v17 offset:2560
    ds_read_b128 v[44:47], v21 offset:0
    ds_read_b64_tr_b16 v[232:233], v17 offset:4096
    ds_read_b64_tr_b16 v[234:235], v17 offset:4608
    ds_read_b128 v[236:239], v22 offset:0
    ds_read_b64_tr_b16 v[240:241], v17 offset:6144
    ds_read_b64_tr_b16 v[242:243], v17 offset:6656
    ds_read_b128 v[244:247], v23 offset:0
    s_waitcnt lgkmcnt(9)
    v_mfma_f32_32x32x16_bf16 v[64:79], v[32:35], v[36:39], v[64:79]
    s_barrier
    ds_read_b64_tr_b16 v[32:33], v17 offset:16384
    ds_read_b64_tr_b16 v[34:35], v17 offset:16896
    ds_read_b128 v[36:39], v20 offset:16384
    v_cvt_pk_bf16_f32 v100, v212, -v216
    v_cvt_pk_bf16_f32 v101, v213, -v217
    v_cvt_pk_bf16_f32 v102, v214, -v218
    v_cvt_pk_bf16_f32 v103, v215, -v219
    v_cndmask_b32 v100, v100, v230, vcc
    v_mul_f32 v220, v212, v228
    s_waitcnt lgkmcnt(9)
    v_mfma_f32_32x32x16_bf16 v[64:79], v[40:43], v[44:47], v[64:79]
    ds_read_b64_tr_b16 v[40:41], v17 offset:18432
    ds_read_b64_tr_b16 v[42:43], v17 offset:18944
    ds_read_b128 v[44:47], v21 offset:16384
    v_mul_f32 v224, v216, v228
    v_fma_f32 v220, -v216, v229, v220
    v_fmac_f32 v224, v212, v229
    v_mul_f32 v221, v213, v228
    v_mul_f32 v225, v217, v228
    v_fma_f32 v221, -v217, v229, v221
    s_waitcnt lgkmcnt(9)
    v_mfma_f32_32x32x16_bf16 v[64:79], v[232:235], v[236:239], v[64:79]
    ds_read_b64_tr_b16 v[232:233], v17 offset:20480
    ds_read_b64_tr_b16 v[234:235], v17 offset:20992
    ds_read_b128 v[236:239], v22 offset:16384
    v_fmac_f32 v225, v213, v229
    v_mul_f32 v222, v214, v228
    v_mul_f32 v226, v218, v228
    v_fma_f32 v222, -v218, v229, v222
    v_fmac_f32 v226, v214, v229
    v_mul_f32 v223, v215, v228
    s_waitcnt lgkmcnt(9)
    v_mfma_f32_32x32x16_bf16 v[64:79], v[240:243], v[244:247], v[64:79]
    ds_read_b64_tr_b16 v[240:241], v17 offset:22528
    ds_read_b64_tr_b16 v[242:243], v17 offset:23040
    ds_read_b128 v[244:247], v23 offset:16384
    v_mul_f32 v227, v219, v228
    v_fma_f32 v223, -v219, v229, v223
    v_fmac_f32 v227, v215, v229
    s_waitcnt lgkmcnt(9)
    v_mfma_f32_32x32x16_bf16 v[64:79], v[32:35], v[36:39], v[64:79]
    s_barrier
    ds_read_b64_tr_b16 v[32:33], v17 offset:32768
    ds_read_b64_tr_b16 v[34:35], v17 offset:33280
    ds_read_b128 v[36:39], v20 offset:32768
    v_cvt_pk_bf16_f32 v104, v220, -v224
    v_cvt_pk_bf16_f32 v105, v221, -v225
    v_cvt_pk_bf16_f32 v106, v222, -v226
    v_cvt_pk_bf16_f32 v107, v223, -v227
    v_mul_f32 v212, v220, v228
    s_waitcnt lgkmcnt(9)
    v_mfma_f32_32x32x16_bf16 v[64:79], v[40:43], v[44:47], v[64:79]
    ds_read_b64_tr_b16 v[40:41], v17 offset:34816
    ds_read_b64_tr_b16 v[42:43], v17 offset:35328
    ds_read_b128 v[44:47], v21 offset:32768
    v_mul_f32 v216, v224, v228
    v_fma_f32 v212, -v224, v229, v212
    v_fmac_f32 v216, v220, v229
    v_mul_f32 v213, v221, v228
    v_mul_f32 v217, v225, v228
    s_waitcnt lgkmcnt(9)
    v_mfma_f32_32x32x16_bf16 v[64:79], v[232:235], v[236:239], v[64:79]
    ds_read_b64_tr_b16 v[232:233], v17 offset:36864
    ds_read_b64_tr_b16 v[234:235], v17 offset:37376
    ds_read_b128 v[236:239], v22 offset:32768
    v_fma_f32 v213, -v225, v229, v213
    v_fmac_f32 v217, v221, v229
    v_mul_f32 v214, v222, v228
    v_mul_f32 v218, v226, v228
    v_fma_f32 v214, -v226, v229, v214
    s_waitcnt lgkmcnt(9)
    v_mfma_f32_32x32x16_bf16 v[64:79], v[240:243], v[244:247], v[64:79]
    ds_read_b64_tr_b16 v[240:241], v17 offset:38912
    ds_read_b64_tr_b16 v[242:243], v17 offset:39424
    ds_read_b128 v[244:247], v23 offset:32768
    v_fmac_f32 v218, v222, v229
    v_mul_f32 v215, v223, v228
    v_mul_f32 v219, v227, v228
    v_fma_f32 v215, -v227, v229, v215
    v_fmac_f32 v219, v223, v229
    s_waitcnt lgkmcnt(9)
    v_mfma_f32_32x32x16_bf16 v[64:79], v[32:35], v[36:39], v[64:79]
    s_barrier
    ds_read_b64_tr_b16 v[32:33], v17 offset:49152
    ds_read_b64_tr_b16 v[34:35], v17 offset:49664
    ds_read_b128 v[36:39], v20 offset:49152
    v_cvt_pk_bf16_f32 v108, v212, -v216
    v_cvt_pk_bf16_f32 v109, v213, -v217
    v_cvt_pk_bf16_f32 v110, v214, -v218
    v_cvt_pk_bf16_f32 v111, v215, -v219
    v_mul_f32 v220, v212, v228
    s_waitcnt lgkmcnt(9)
    v_mfma_f32_32x32x16_bf16 v[64:79], v[40:43], v[44:47], v[64:79]
    ds_read_b64_tr_b16 v[40:41], v17 offset:51200
    ds_read_b64_tr_b16 v[42:43], v17 offset:51712
    ds_read_b128 v[44:47], v21 offset:49152
    v_mul_f32 v224, v216, v228
    v_fma_f32 v220, -v216, v229, v220
    v_fmac_f32 v224, v212, v229
    v_mul_f32 v221, v213, v228
    v_mul_f32 v225, v217, v228
    s_waitcnt lgkmcnt(9)
    v_mfma_f32_32x32x16_bf16 v[64:79], v[232:235], v[236:239], v[64:79]
    ds_read_b64_tr_b16 v[232:233], v17 offset:53248
    ds_read_b64_tr_b16 v[234:235], v17 offset:53760
    ds_read_b128 v[236:239], v22 offset:49152
    v_fma_f32 v221, -v217, v229, v221
    v_fmac_f32 v225, v213, v229
    v_mul_f32 v222, v214, v228
    v_mul_f32 v226, v218, v228
    v_fma_f32 v222, -v218, v229, v222
    s_waitcnt lgkmcnt(9)
    v_mfma_f32_32x32x16_bf16 v[64:79], v[240:243], v[244:247], v[64:79]
    ds_read_b64_tr_b16 v[240:241], v17 offset:55296
    ds_read_b64_tr_b16 v[242:243], v17 offset:55808
    ds_read_b128 v[244:247], v23 offset:49152
    v_fmac_f32 v226, v214, v229
    v_mul_f32 v223, v215, v228
    v_mul_f32 v227, v219, v228
    v_fma_f32 v223, -v219, v229, v223
    v_fmac_f32 v227, v215, v229
    s_waitcnt lgkmcnt(9)
    v_mfma_f32_32x32x16_bf16 v[64:79], v[32:35], v[36:39], v[64:79]
    s_barrier
    ds_read_b64_tr_b16 v[32:33], v48 offset:0
    ds_read_b64_tr_b16 v[34:35], v48 offset:512
    ds_read_b128 v[36:39], v50 offset:0
    v_cvt_pk_bf16_f32 v112, v220, -v224
    v_cvt_pk_bf16_f32 v113, v221, -v225
    v_cvt_pk_bf16_f32 v114, v222, -v226
    v_cvt_pk_bf16_f32 v115, v223, -v227
    v_mul_f32 v212, v220, v228
    s_waitcnt lgkmcnt(9)
    v_mfma_f32_32x32x16_bf16 v[64:79], v[40:43], v[44:47], v[64:79]
    ds_read_b64_tr_b16 v[40:41], v48 offset:2048
    ds_read_b64_tr_b16 v[42:43], v48 offset:2560
    ds_read_b128 v[44:47], v51 offset:0
    v_mul_f32 v216, v224, v228
    v_fma_f32 v212, -v224, v229, v212
    v_fmac_f32 v216, v220, v229
    v_mul_f32 v213, v221, v228
    v_mul_f32 v217, v225, v228
    s_waitcnt lgkmcnt(9)
    v_mfma_f32_32x32x16_bf16 v[64:79], v[232:235], v[236:239], v[64:79]
    ds_read_b64_tr_b16 v[232:233], v48 offset:4096
    ds_read_b64_tr_b16 v[234:235], v48 offset:4608
    ds_read_b128 v[236:239], v52 offset:0
    v_fma_f32 v213, -v225, v229, v213
    v_fmac_f32 v217, v221, v229
    v_mul_f32 v214, v222, v228
    v_mul_f32 v218, v226, v228
    v_fma_f32 v214, -v226, v229, v214
    s_waitcnt lgkmcnt(9)
    v_mfma_f32_32x32x16_bf16 v[64:79], v[240:243], v[244:247], v[64:79]
    ds_read_b64_tr_b16 v[240:241], v48 offset:6144
    ds_read_b64_tr_b16 v[242:243], v48 offset:6656
    ds_read_b128 v[244:247], v53 offset:0
    v_fmac_f32 v218, v222, v229
    v_mul_f32 v215, v223, v228
    v_mul_f32 v219, v227, v228
    v_fma_f32 v215, -v227, v229, v215
    v_fmac_f32 v219, v223, v229
    s_waitcnt lgkmcnt(9)
    v_mfma_f32_32x32x16_bf16 v[64:79], v[32:35], v[36:39], v[64:79]
    s_barrier
    ds_read_b64_tr_b16 v[32:33], v48 offset:16384
    ds_read_b64_tr_b16 v[34:35], v48 offset:16896
    ds_read_b128 v[36:39], v50 offset:16384
    v_cvt_pk_bf16_f32 v116, v212, -v216
    v_cvt_pk_bf16_f32 v117, v213, -v217
    v_cvt_pk_bf16_f32 v118, v214, -v218
    v_cvt_pk_bf16_f32 v119, v215, -v219
    v_mul_f32 v220, v212, v228
    s_waitcnt lgkmcnt(9)
    v_mfma_f32_32x32x16_bf16 v[64:79], v[40:43], v[44:47], v[64:79]
    ds_read_b64_tr_b16 v[40:41], v48 offset:18432
    ds_read_b64_tr_b16 v[42:43], v48 offset:18944
    ds_read_b128 v[44:47], v51 offset:16384
    v_mul_f32 v224, v216, v228
    v_fma_f32 v220, -v216, v229, v220
    v_fmac_f32 v224, v212, v229
    v_mul_f32 v221, v213, v228
    v_mul_f32 v225, v217, v228
    s_waitcnt lgkmcnt(9)
    v_mfma_f32_32x32x16_bf16 v[64:79], v[232:235], v[236:239], v[64:79]
    ds_read_b64_tr_b16 v[232:233], v48 offset:20480
    ds_read_b64_tr_b16 v[234:235], v48 offset:20992
    ds_read_b128 v[236:239], v52 offset:16384
    v_fma_f32 v221, -v217, v229, v221
    v_fmac_f32 v225, v213, v229
    v_mul_f32 v222, v214, v228
    v_mul_f32 v226, v218, v228
    v_fma_f32 v222, -v218, v229, v222
    s_waitcnt lgkmcnt(9)
    v_mfma_f32_32x32x16_bf16 v[64:79], v[240:243], v[244:247], v[64:79]
    ds_read_b64_tr_b16 v[240:241], v48 offset:22528
    ds_read_b64_tr_b16 v[242:243], v48 offset:23040
    ds_read_b128 v[244:247], v53 offset:16384
    v_fmac_f32 v226, v214, v229
    v_mul_f32 v223, v215, v228
    v_mul_f32 v227, v219, v228
    v_fma_f32 v223, -v219, v229, v223
    v_fmac_f32 v227, v215, v229
    s_waitcnt lgkmcnt(9)
    v_mfma_f32_32x32x16_bf16 v[64:79], v[32:35], v[36:39], v[64:79]
    s_barrier
    ds_read_b64_tr_b16 v[32:33], v48 offset:32768
    ds_read_b64_tr_b16 v[34:35], v48 offset:33280
    ds_read_b128 v[36:39], v50 offset:32768
    v_cvt_pk_bf16_f32 v120, v220, -v224
    v_cvt_pk_bf16_f32 v121, v221, -v225
    v_cvt_pk_bf16_f32 v122, v222, -v226
    v_cvt_pk_bf16_f32 v123, v223, -v227
    v_mul_f32 v212, v220, v228
    s_waitcnt lgkmcnt(9)
    v_mfma_f32_32x32x16_bf16 v[64:79], v[40:43], v[44:47], v[64:79]
    ds_read_b64_tr_b16 v[40:41], v48 offset:34816
    ds_read_b64_tr_b16 v[42:43], v48 offset:35328
    ds_read_b128 v[44:47], v51 offset:32768
    v_mul_f32 v216, v224, v228
    v_fma_f32 v212, -v224, v229, v212
    v_fmac_f32 v216, v220, v229
    v_mul_f32 v213, v221, v228
    v_mul_f32 v217, v225, v228
    s_waitcnt lgkmcnt(9)
    v_mfma_f32_32x32x16_bf16 v[64:79], v[232:235], v[236:239], v[64:79]
    ds_read_b64_tr_b16 v[232:233], v48 offset:36864
    ds_read_b64_tr_b16 v[234:235], v48 offset:37376
    ds_read_b128 v[236:239], v52 offset:32768
    v_fma_f32 v213, -v225, v229, v213
    v_fmac_f32 v217, v221, v229
    v_mul_f32 v214, v222, v228
    v_mul_f32 v218, v226, v228
    v_fma_f32 v214, -v226, v229, v214
    s_waitcnt lgkmcnt(9)
    v_mfma_f32_32x32x16_bf16 v[64:79], v[240:243], v[244:247], v[64:79]
    ds_read_b64_tr_b16 v[240:241], v48 offset:38912
    ds_read_b64_tr_b16 v[242:243], v48 offset:39424
    ds_read_b128 v[244:247], v53 offset:32768
    v_fmac_f32 v218, v222, v229
    v_mul_f32 v215, v223, v228
    v_mul_f32 v219, v227, v228
    v_fma_f32 v215, -v227, v229, v215
    v_fmac_f32 v219, v223, v229
    s_waitcnt lgkmcnt(9)
    v_mfma_f32_32x32x16_bf16 v[64:79], v[32:35], v[36:39], v[64:79]
    s_barrier
    ds_read_b64_tr_b16 v[32:33], v17 offset:0
    ds_read_b64_tr_b16 v[34:35], v17 offset:512
    ds_read_b128 v[36:39], v20 offset:0
    v_cvt_pk_bf16_f32 v124, v212, -v216
    v_cvt_pk_bf16_f32 v125, v213, -v217
    v_cvt_pk_bf16_f32 v126, v214, -v218
    v_cvt_pk_bf16_f32 v127, v215, -v219
    v_mul_f32 v220, v212, v228
    s_waitcnt lgkmcnt(9)
    v_mfma_f32_32x32x16_bf16 v[64:79], v[40:43], v[44:47], v[64:79]
    ds_read_b64_tr_b16 v[40:41], v17 offset:2048
    ds_read_b64_tr_b16 v[42:43], v17 offset:2560
    ds_read_b128 v[44:47], v21 offset:0
    v_mul_f32 v224, v216, v228
    v_fma_f32 v220, -v216, v229, v220
    v_fmac_f32 v224, v212, v229
    v_mul_f32 v221, v213, v228
    v_mul_f32 v225, v217, v228
    s_waitcnt lgkmcnt(9)
    v_mfma_f32_32x32x16_bf16 v[64:79], v[232:235], v[236:239], v[64:79]
    ds_read_b64_tr_b16 v[232:233], v17 offset:4096
    ds_read_b64_tr_b16 v[234:235], v17 offset:4608
    ds_read_b128 v[236:239], v22 offset:0
    v_fma_f32 v221, -v217, v229, v221
    v_fmac_f32 v225, v213, v229
    v_mul_f32 v222, v214, v228
    v_mul_f32 v226, v218, v228
    v_fma_f32 v222, -v218, v229, v222
    s_waitcnt lgkmcnt(9)
    v_mfma_f32_32x32x16_bf16 v[64:79], v[240:243], v[244:247], v[64:79]
    ds_read_b64_tr_b16 v[240:241], v17 offset:6144
    ds_read_b64_tr_b16 v[242:243], v17 offset:6656
    ds_read_b128 v[244:247], v23 offset:0
    v_fmac_f32 v226, v214, v229
    v_mul_f32 v223, v215, v228
    v_mul_f32 v227, v219, v228
    v_fma_f32 v223, -v219, v229, v223
    v_fmac_f32 v227, v215, v229
    s_waitcnt lgkmcnt(9)
    v_mfma_f32_32x32x16_bf16 v[64:79], v[32:35], v[36:39], v[64:79]
    s_barrier
    ds_read_b64_tr_b16 v[32:33], v17 offset:16384
    ds_read_b64_tr_b16 v[34:35], v17 offset:16896
    ds_read_b128 v[36:39], v20 offset:16384
    v_cvt_pk_bf16_f32 v128, v220, -v224
    v_cvt_pk_bf16_f32 v129, v221, -v225
    v_cvt_pk_bf16_f32 v130, v222, -v226
    v_cvt_pk_bf16_f32 v131, v223, -v227
    v_mul_f32 v212, v220, v228
    s_waitcnt lgkmcnt(9)
    v_mfma_f32_32x32x16_bf16 v[64:79], v[40:43], v[44:47], v[64:79]
    ds_read_b64_tr_b16 v[40:41], v17 offset:18432
    ds_read_b64_tr_b16 v[42:43], v17 offset:18944
    ds_read_b128 v[44:47], v21 offset:16384
    v_mul_f32 v216, v224, v228
    v_fma_f32 v212, -v224, v229, v212
    v_fmac_f32 v216, v220, v229
    v_mul_f32 v213, v221, v228
    v_mul_f32 v217, v225, v228
    s_waitcnt lgkmcnt(9)
    v_mfma_f32_32x32x16_bf16 v[64:79], v[232:235], v[236:239], v[64:79]
    ds_read_b64_tr_b16 v[232:233], v17 offset:20480
    ds_read_b64_tr_b16 v[234:235], v17 offset:20992
    ds_read_b128 v[236:239], v22 offset:16384
    v_fma_f32 v213, -v225, v229, v213
    v_fmac_f32 v217, v221, v229
    v_mul_f32 v214, v222, v228
    v_mul_f32 v218, v226, v228
    v_fma_f32 v214, -v226, v229, v214
    s_waitcnt lgkmcnt(9)
    v_mfma_f32_32x32x16_bf16 v[64:79], v[240:243], v[244:247], v[64:79]
    ds_read_b64_tr_b16 v[240:241], v17 offset:22528
    ds_read_b64_tr_b16 v[242:243], v17 offset:23040
    ds_read_b128 v[244:247], v23 offset:16384
    v_fmac_f32 v218, v222, v229
    v_mul_f32 v215, v223, v228
    v_mul_f32 v219, v227, v228
    v_fma_f32 v215, -v227, v229, v215
    v_fmac_f32 v219, v223, v229
    s_waitcnt lgkmcnt(9)
    v_mfma_f32_32x32x16_bf16 v[64:79], v[32:35], v[36:39], v[64:79]
    s_barrier
    ds_read_b64_tr_b16 v[32:33], v17 offset:32768
    ds_read_b64_tr_b16 v[34:35], v17 offset:33280
    ds_read_b128 v[36:39], v20 offset:32768
    v_cvt_pk_bf16_f32 v132, v212, -v216
    v_cvt_pk_bf16_f32 v133, v213, -v217
    v_cvt_pk_bf16_f32 v134, v214, -v218
    v_cvt_pk_bf16_f32 v135, v215, -v219
    v_mul_f32 v220, v212, v228
    s_waitcnt lgkmcnt(9)
    v_mfma_f32_32x32x16_bf16 v[64:79], v[40:43], v[44:47], v[64:79]
    ds_read_b64_tr_b16 v[40:41], v17 offset:34816
    ds_read_b64_tr_b16 v[42:43], v17 offset:35328
    ds_read_b128 v[44:47], v21 offset:32768
    v_mul_f32 v224, v216, v228
    v_fma_f32 v220, -v216, v229, v220
    v_fmac_f32 v224, v212, v229
    v_mul_f32 v221, v213, v228
    v_mul_f32 v225, v217, v228
    s_waitcnt lgkmcnt(9)
    v_mfma_f32_32x32x16_bf16 v[64:79], v[232:235], v[236:239], v[64:79]
    ds_read_b64_tr_b16 v[232:233], v17 offset:36864
    ds_read_b64_tr_b16 v[234:235], v17 offset:37376
    ds_read_b128 v[236:239], v22 offset:32768
    v_fma_f32 v221, -v217, v229, v221
    v_fmac_f32 v225, v213, v229
    v_mul_f32 v222, v214, v228
    v_mul_f32 v226, v218, v228
    v_fma_f32 v222, -v218, v229, v222
    s_waitcnt lgkmcnt(9)
    v_mfma_f32_32x32x16_bf16 v[64:79], v[240:243], v[244:247], v[64:79]
    ds_read_b64_tr_b16 v[240:241], v17 offset:38912
    ds_read_b64_tr_b16 v[242:243], v17 offset:39424
    ds_read_b128 v[244:247], v23 offset:32768
    v_fmac_f32 v226, v214, v229
    v_mul_f32 v223, v215, v228
    v_mul_f32 v227, v219, v228
    v_fma_f32 v223, -v219, v229, v223
    v_fmac_f32 v227, v215, v229
    s_waitcnt lgkmcnt(9)
    v_mfma_f32_32x32x16_bf16 v[64:79], v[32:35], v[36:39], v[64:79]
    s_barrier
    ds_read_b64_tr_b16 v[32:33], v17 offset:49152
    ds_read_b64_tr_b16 v[34:35], v17 offset:49664
    ds_read_b128 v[36:39], v20 offset:49152
    v_cvt_pk_bf16_f32 v136, v220, -v224
    v_cvt_pk_bf16_f32 v137, v221, -v225
    v_cvt_pk_bf16_f32 v138, v222, -v226
    v_cvt_pk_bf16_f32 v139, v223, -v227
    v_mul_f32 v212, v220, v228
    s_waitcnt lgkmcnt(9)
    v_mfma_f32_32x32x16_bf16 v[64:79], v[40:43], v[44:47], v[64:79]
    ds_read_b64_tr_b16 v[40:41], v17 offset:51200
    ds_read_b64_tr_b16 v[42:43], v17 offset:51712
    ds_read_b128 v[44:47], v21 offset:49152
    v_mul_f32 v216, v224, v228
    v_fma_f32 v212, -v224, v229, v212
    v_fmac_f32 v216, v220, v229
    v_mul_f32 v213, v221, v228
    v_mul_f32 v217, v225, v228
    s_waitcnt lgkmcnt(9)
    v_mfma_f32_32x32x16_bf16 v[64:79], v[232:235], v[236:239], v[64:79]
    ds_read_b64_tr_b16 v[232:233], v17 offset:53248
    ds_read_b64_tr_b16 v[234:235], v17 offset:53760
    ds_read_b128 v[236:239], v22 offset:49152
    v_fma_f32 v213, -v225, v229, v213
    v_fmac_f32 v217, v221, v229
    v_mul_f32 v214, v222, v228
    v_mul_f32 v218, v226, v228
    v_fma_f32 v214, -v226, v229, v214
    s_waitcnt lgkmcnt(9)
    v_mfma_f32_32x32x16_bf16 v[64:79], v[240:243], v[244:247], v[64:79]
    ds_read_b64_tr_b16 v[240:241], v17 offset:55296
    ds_read_b64_tr_b16 v[242:243], v17 offset:55808
    ds_read_b128 v[244:247], v23 offset:49152
    v_fmac_f32 v218, v222, v229
    v_mul_f32 v215, v223, v228
    v_mul_f32 v219, v227, v228
    v_fma_f32 v215, -v227, v229, v215
    v_fmac_f32 v219, v223, v229
    s_waitcnt lgkmcnt(9)
    v_mfma_f32_32x32x16_bf16 v[64:79], v[32:35], v[36:39], v[64:79]
    s_barrier
    ds_read_b64_tr_b16 v[32:33], v48 offset:0
    ds_read_b64_tr_b16 v[34:35], v48 offset:512
    ds_read_b128 v[36:39], v50 offset:0
    v_cvt_pk_bf16_f32 v140, v212, -v216
    v_cvt_pk_bf16_f32 v141, v213, -v217
    v_cvt_pk_bf16_f32 v142, v214, -v218
    v_cvt_pk_bf16_f32 v143, v215, -v219
    v_mul_f32 v220, v212, v228
    s_waitcnt lgkmcnt(9)
    v_mfma_f32_32x32x16_bf16 v[64:79], v[40:43], v[44:47], v[64:79]
    ds_read_b64_tr_b16 v[40:41], v48 offset:2048
    ds_read_b64_tr_b16 v[42:43], v48 offset:2560
    ds_read_b128 v[44:47], v51 offset:0
    v_mul_f32 v224, v216, v228
    v_fma_f32 v220, -v216, v229, v220
    v_fmac_f32 v224, v212, v229
    v_mul_f32 v221, v213, v228
    v_mul_f32 v225, v217, v228
    s_waitcnt lgkmcnt(9)
    v_mfma_f32_32x32x16_bf16 v[64:79], v[232:235], v[236:239], v[64:79]
    ds_read_b64_tr_b16 v[232:233], v48 offset:4096
    ds_read_b64_tr_b16 v[234:235], v48 offset:4608
    ds_read_b128 v[236:239], v52 offset:0
    v_fma_f32 v221, -v217, v229, v221
    v_fmac_f32 v225, v213, v229
    v_mul_f32 v222, v214, v228
    v_mul_f32 v226, v218, v228
    v_fma_f32 v222, -v218, v229, v222
    s_waitcnt lgkmcnt(9)
    v_mfma_f32_32x32x16_bf16 v[64:79], v[240:243], v[244:247], v[64:79]
    ds_read_b64_tr_b16 v[240:241], v48 offset:6144
    ds_read_b64_tr_b16 v[242:243], v48 offset:6656
    ds_read_b128 v[244:247], v53 offset:0
    v_fmac_f32 v226, v214, v229
    v_mul_f32 v223, v215, v228
    v_mul_f32 v227, v219, v228
    v_fma_f32 v223, -v219, v229, v223
    v_fmac_f32 v227, v215, v229
    s_waitcnt lgkmcnt(9)
    v_mfma_f32_32x32x16_bf16 v[64:79], v[32:35], v[36:39], v[64:79]
    s_barrier
    ds_read_b64_tr_b16 v[32:33], v48 offset:16384
    ds_read_b64_tr_b16 v[34:35], v48 offset:16896
    ds_read_b128 v[36:39], v50 offset:16384
    v_cvt_pk_bf16_f32 v144, v220, -v224
    v_cvt_pk_bf16_f32 v145, v221, -v225
    v_cvt_pk_bf16_f32 v146, v222, -v226
    v_cvt_pk_bf16_f32 v147, v223, -v227
    v_mul_f32 v212, v220, v228
    s_waitcnt lgkmcnt(9)
    v_mfma_f32_32x32x16_bf16 v[64:79], v[40:43], v[44:47], v[64:79]
    ds_read_b64_tr_b16 v[40:41], v48 offset:18432
    ds_read_b64_tr_b16 v[42:43], v48 offset:18944
    ds_read_b128 v[44:47], v51 offset:16384
    v_mul_f32 v216, v224, v228
    v_fma_f32 v212, -v224, v229, v212
    v_fmac_f32 v216, v220, v229
    v_mul_f32 v213, v221, v228
    v_mul_f32 v217, v225, v228
    s_waitcnt lgkmcnt(9)
    v_mfma_f32_32x32x16_bf16 v[64:79], v[232:235], v[236:239], v[64:79]
    ds_read_b64_tr_b16 v[232:233], v48 offset:20480
    ds_read_b64_tr_b16 v[234:235], v48 offset:20992
    ds_read_b128 v[236:239], v52 offset:16384
    v_fma_f32 v213, -v225, v229, v213
    v_fmac_f32 v217, v221, v229
    v_mul_f32 v214, v222, v228
    v_mul_f32 v218, v226, v228
    v_fma_f32 v214, -v226, v229, v214
    s_waitcnt lgkmcnt(9)
    v_mfma_f32_32x32x16_bf16 v[64:79], v[240:243], v[244:247], v[64:79]
    ds_read_b64_tr_b16 v[240:241], v48 offset:22528
    ds_read_b64_tr_b16 v[242:243], v48 offset:23040
    ds_read_b128 v[244:247], v53 offset:16384
    v_fmac_f32 v218, v222, v229
    v_mul_f32 v215, v223, v228
    v_mul_f32 v219, v227, v228
    v_fma_f32 v215, -v227, v229, v215
    v_fmac_f32 v219, v223, v229
    s_waitcnt lgkmcnt(9)
    v_mfma_f32_32x32x16_bf16 v[64:79], v[32:35], v[36:39], v[64:79]
    s_barrier
    ds_read_b64_tr_b16 v[32:33], v48 offset:32768
    ds_read_b64_tr_b16 v[34:35], v48 offset:33280
    ds_read_b128 v[36:39], v50 offset:32768
    v_cvt_pk_bf16_f32 v148, v212, -v216
    v_cvt_pk_bf16_f32 v149, v213, -v217
    v_cvt_pk_bf16_f32 v150, v214, -v218
    v_cvt_pk_bf16_f32 v151, v215, -v219
    v_mul_f32 v220, v212, v228
    s_waitcnt lgkmcnt(9)
    v_mfma_f32_32x32x16_bf16 v[64:79], v[40:43], v[44:47], v[64:79]
    ds_read_b64_tr_b16 v[40:41], v48 offset:34816
    ds_read_b64_tr_b16 v[42:43], v48 offset:35328
    ds_read_b128 v[44:47], v51 offset:32768
    v_mul_f32 v224, v216, v228
    v_fma_f32 v220, -v216, v229, v220
    v_fmac_f32 v224, v212, v229
    v_mul_f32 v221, v213, v228
    v_mul_f32 v225, v217, v228
    s_waitcnt lgkmcnt(9)
    v_mfma_f32_32x32x16_bf16 v[64:79], v[232:235], v[236:239], v[64:79]
    ds_read_b64_tr_b16 v[232:233], v48 offset:36864
    ds_read_b64_tr_b16 v[234:235], v48 offset:37376
    ds_read_b128 v[236:239], v52 offset:32768
    v_fma_f32 v221, -v217, v229, v221
    v_fmac_f32 v225, v213, v229
    v_mul_f32 v222, v214, v228
    v_mul_f32 v226, v218, v228
    v_fma_f32 v222, -v218, v229, v222
    s_waitcnt lgkmcnt(9)
    v_mfma_f32_32x32x16_bf16 v[64:79], v[240:243], v[244:247], v[64:79]
    ds_read_b64_tr_b16 v[240:241], v48 offset:38912
    ds_read_b64_tr_b16 v[242:243], v48 offset:39424
    ds_read_b128 v[244:247], v53 offset:32768
    v_fmac_f32 v226, v214, v229
    v_mul_f32 v223, v215, v228
    v_mul_f32 v227, v219, v228
    v_fma_f32 v223, -v219, v229, v223
    v_fmac_f32 v227, v215, v229
    s_waitcnt lgkmcnt(9)
    v_mfma_f32_32x32x16_bf16 v[64:79], v[32:35], v[36:39], v[64:79]
    s_barrier
    ds_read_b64_tr_b16 v[32:33], v17 offset:0
    ds_read_b64_tr_b16 v[34:35], v17 offset:512
    ds_read_b128 v[36:39], v20 offset:0
    v_cvt_pk_bf16_f32 v152, v220, -v224
    v_cvt_pk_bf16_f32 v153, v221, -v225
    v_cvt_pk_bf16_f32 v154, v222, -v226
    v_cvt_pk_bf16_f32 v155, v223, -v227
    v_mul_f32 v212, v220, v228
    s_waitcnt lgkmcnt(9)
    v_mfma_f32_32x32x16_bf16 v[64:79], v[40:43], v[44:47], v[64:79]
    ds_read_b64_tr_b16 v[40:41], v17 offset:2048
    ds_read_b64_tr_b16 v[42:43], v17 offset:2560
    ds_read_b128 v[44:47], v21 offset:0
    v_mul_f32 v216, v224, v228
    v_fma_f32 v212, -v224, v229, v212
    v_fmac_f32 v216, v220, v229
    v_mul_f32 v213, v221, v228
    v_mul_f32 v217, v225, v228
    s_waitcnt lgkmcnt(9)
    v_mfma_f32_32x32x16_bf16 v[64:79], v[232:235], v[236:239], v[64:79]
    ds_read_b64_tr_b16 v[232:233], v17 offset:4096
    ds_read_b64_tr_b16 v[234:235], v17 offset:4608
    ds_read_b128 v[236:239], v22 offset:0
    v_fma_f32 v213, -v225, v229, v213
    v_fmac_f32 v217, v221, v229
    v_mul_f32 v214, v222, v228
    v_mul_f32 v218, v226, v228
    v_fma_f32 v214, -v226, v229, v214
    s_waitcnt lgkmcnt(9)
    v_mfma_f32_32x32x16_bf16 v[64:79], v[240:243], v[244:247], v[64:79]
    ds_read_b64_tr_b16 v[240:241], v17 offset:6144
    ds_read_b64_tr_b16 v[242:243], v17 offset:6656
    ds_read_b128 v[244:247], v23 offset:0
    v_fmac_f32 v218, v222, v229
    v_mul_f32 v215, v223, v228
    v_mul_f32 v219, v227, v228
    v_fma_f32 v215, -v227, v229, v215
    v_fmac_f32 v219, v223, v229
    s_waitcnt lgkmcnt(9)
    v_mfma_f32_32x32x16_bf16 v[64:79], v[32:35], v[36:39], v[64:79]
    s_barrier
    ds_read_b64_tr_b16 v[32:33], v17 offset:16384
    ds_read_b64_tr_b16 v[34:35], v17 offset:16896
    ds_read_b128 v[36:39], v20 offset:16384
    v_cvt_pk_bf16_f32 v156, v212, -v216
    v_cvt_pk_bf16_f32 v157, v213, -v217
    v_cvt_pk_bf16_f32 v158, v214, -v218
    v_cvt_pk_bf16_f32 v159, v215, -v219
    v_mul_f32 v220, v212, v228
    s_waitcnt lgkmcnt(9)
    v_mfma_f32_32x32x16_bf16 v[64:79], v[40:43], v[44:47], v[64:79]
    ds_read_b64_tr_b16 v[40:41], v17 offset:18432
    ds_read_b64_tr_b16 v[42:43], v17 offset:18944
    ds_read_b128 v[44:47], v21 offset:16384
    v_mul_f32 v224, v216, v228
    v_fma_f32 v220, -v216, v229, v220
    v_fmac_f32 v224, v212, v229
    v_mul_f32 v221, v213, v228
    v_mul_f32 v225, v217, v228
    s_waitcnt lgkmcnt(9)
    v_mfma_f32_32x32x16_bf16 v[64:79], v[232:235], v[236:239], v[64:79]
    ds_read_b64_tr_b16 v[232:233], v17 offset:20480
    ds_read_b64_tr_b16 v[234:235], v17 offset:20992
    ds_read_b128 v[236:239], v22 offset:16384
    v_fma_f32 v221, -v217, v229, v221
    v_fmac_f32 v225, v213, v229
    v_mul_f32 v222, v214, v228
    v_mul_f32 v226, v218, v228
    v_fma_f32 v222, -v218, v229, v222
    s_waitcnt lgkmcnt(9)
    v_mfma_f32_32x32x16_bf16 v[64:79], v[240:243], v[244:247], v[64:79]
    ds_read_b64_tr_b16 v[240:241], v17 offset:22528
    ds_read_b64_tr_b16 v[242:243], v17 offset:23040
    ds_read_b128 v[244:247], v23 offset:16384
    v_fmac_f32 v226, v214, v229
    v_mul_f32 v223, v215, v228
    v_mul_f32 v227, v219, v228
    v_fma_f32 v223, -v219, v229, v223
    v_fmac_f32 v227, v215, v229
    s_waitcnt lgkmcnt(9)
    v_mfma_f32_32x32x16_bf16 v[64:79], v[32:35], v[36:39], v[64:79]
    s_barrier
    ds_read_b64_tr_b16 v[32:33], v17 offset:32768
    ds_read_b64_tr_b16 v[34:35], v17 offset:33280
    ds_read_b128 v[36:39], v20 offset:32768
    v_cvt_pk_bf16_f32 v160, v220, -v224
    v_cvt_pk_bf16_f32 v161, v221, -v225
    v_cvt_pk_bf16_f32 v162, v222, -v226
    v_cvt_pk_bf16_f32 v163, v223, -v227
    v_mul_f32 v212, v220, v228
    s_waitcnt lgkmcnt(9)
    v_mfma_f32_32x32x16_bf16 v[64:79], v[40:43], v[44:47], v[64:79]
    ds_read_b64_tr_b16 v[40:41], v17 offset:34816
    ds_read_b64_tr_b16 v[42:43], v17 offset:35328
    ds_read_b128 v[44:47], v21 offset:32768
    v_mul_f32 v216, v224, v228
    v_fma_f32 v212, -v224, v229, v212
    v_fmac_f32 v216, v220, v229
    v_mul_f32 v213, v221, v228
    v_mul_f32 v217, v225, v228
    s_waitcnt lgkmcnt(9)
    v_mfma_f32_32x32x16_bf16 v[64:79], v[232:235], v[236:239], v[64:79]
    ds_read_b64_tr_b16 v[232:233], v17 offset:36864
    ds_read_b64_tr_b16 v[234:235], v17 offset:37376
    ds_read_b128 v[236:239], v22 offset:32768
    v_fma_f32 v213, -v225, v229, v213
    v_fmac_f32 v217, v221, v229
    v_mul_f32 v214, v222, v228
    v_mul_f32 v218, v226, v228
    v_fma_f32 v214, -v226, v229, v214
    s_waitcnt lgkmcnt(9)
    v_mfma_f32_32x32x16_bf16 v[64:79], v[240:243], v[244:247], v[64:79]
    ds_read_b64_tr_b16 v[240:241], v17 offset:38912
    ds_read_b64_tr_b16 v[242:243], v17 offset:39424
    ds_read_b128 v[244:247], v23 offset:32768
    v_fmac_f32 v218, v222, v229
    v_mul_f32 v215, v223, v228
    v_mul_f32 v219, v227, v228
    v_fma_f32 v215, -v227, v229, v215
    v_fmac_f32 v219, v223, v229
    s_waitcnt lgkmcnt(9)
    v_mfma_f32_32x32x16_bf16 v[64:79], v[32:35], v[36:39], v[64:79]
    s_barrier
    ds_read_b64_tr_b16 v[32:33], v17 offset:49152
    ds_read_b64_tr_b16 v[34:35], v17 offset:49664
    ds_read_b128 v[36:39], v20 offset:49152
    v_cvt_pk_bf16_f32 v164, v212, -v216
    v_cvt_pk_bf16_f32 v165, v213, -v217
    v_cvt_pk_bf16_f32 v166, v214, -v218
    v_cvt_pk_bf16_f32 v167, v215, -v219
    v_mul_f32 v220, v212, v228
    s_waitcnt lgkmcnt(9)
    v_mfma_f32_32x32x16_bf16 v[64:79], v[40:43], v[44:47], v[64:79]
    ds_read_b64_tr_b16 v[40:41], v17 offset:51200
    ds_read_b64_tr_b16 v[42:43], v17 offset:51712
    ds_read_b128 v[44:47], v21 offset:49152
    v_mul_f32 v224, v216, v228
    v_fma_f32 v220, -v216, v229, v220
    v_fmac_f32 v224, v212, v229
    v_mul_f32 v221, v213, v228
    v_mul_f32 v225, v217, v228
    s_waitcnt lgkmcnt(9)
    v_mfma_f32_32x32x16_bf16 v[64:79], v[232:235], v[236:239], v[64:79]
    ds_read_b64_tr_b16 v[232:233], v17 offset:53248
    ds_read_b64_tr_b16 v[234:235], v17 offset:53760
    ds_read_b128 v[236:239], v22 offset:49152
    v_fma_f32 v221, -v217, v229, v221
    v_fmac_f32 v225, v213, v229
    v_mul_f32 v222, v214, v228
    v_mul_f32 v226, v218, v228
    v_fma_f32 v222, -v218, v229, v222
    s_waitcnt lgkmcnt(9)
    v_mfma_f32_32x32x16_bf16 v[64:79], v[240:243], v[244:247], v[64:79]
    ds_read_b64_tr_b16 v[240:241], v17 offset:55296
    ds_read_b64_tr_b16 v[242:243], v17 offset:55808
    ds_read_b128 v[244:247], v23 offset:49152
    v_fmac_f32 v226, v214, v229
    v_mul_f32 v223, v215, v228
    v_mul_f32 v227, v219, v228
    v_fma_f32 v223, -v219, v229, v223
    v_fmac_f32 v227, v215, v229
    s_waitcnt lgkmcnt(9)
    v_mfma_f32_32x32x16_bf16 v[64:79], v[32:35], v[36:39], v[64:79]
    s_barrier
    ds_read_b64_tr_b16 v[32:33], v48 offset:0
    ds_read_b64_tr_b16 v[34:35], v48 offset:512
    ds_read_b128 v[36:39], v50 offset:0
    v_cvt_pk_bf16_f32 v168, v220, -v224
    v_cvt_pk_bf16_f32 v169, v221, -v225
    v_cvt_pk_bf16_f32 v170, v222, -v226
    v_cvt_pk_bf16_f32 v171, v223, -v227
    v_mul_f32 v212, v220, v228
    s_waitcnt lgkmcnt(9)
    v_mfma_f32_32x32x16_bf16 v[64:79], v[40:43], v[44:47], v[64:79]
    ds_read_b64_tr_b16 v[40:41], v48 offset:2048
    ds_read_b64_tr_b16 v[42:43], v48 offset:2560
    ds_read_b128 v[44:47], v51 offset:0
    v_mul_f32 v216, v224, v228
    v_fma_f32 v212, -v224, v229, v212
    v_fmac_f32 v216, v220, v229
    v_mul_f32 v213, v221, v228
    v_mul_f32 v217, v225, v228
    s_waitcnt lgkmcnt(9)
    v_mfma_f32_32x32x16_bf16 v[64:79], v[232:235], v[236:239], v[64:79]
    ds_read_b64_tr_b16 v[232:233], v48 offset:4096
    ds_read_b64_tr_b16 v[234:235], v48 offset:4608
    ds_read_b128 v[236:239], v52 offset:0
    v_fma_f32 v213, -v225, v229, v213
    v_fmac_f32 v217, v221, v229
    v_mul_f32 v214, v222, v228
    v_mul_f32 v218, v226, v228
    v_fma_f32 v214, -v226, v229, v214
    s_waitcnt lgkmcnt(9)
    v_mfma_f32_32x32x16_bf16 v[64:79], v[240:243], v[244:247], v[64:79]
    ds_read_b64_tr_b16 v[240:241], v48 offset:6144
    ds_read_b64_tr_b16 v[242:243], v48 offset:6656
    ds_read_b128 v[244:247], v53 offset:0
    v_fmac_f32 v218, v222, v229
    v_mul_f32 v215, v223, v228
    v_mul_f32 v219, v227, v228
    v_fma_f32 v215, -v227, v229, v215
    v_fmac_f32 v219, v223, v229
    s_waitcnt lgkmcnt(9)
    v_mfma_f32_32x32x16_bf16 v[64:79], v[32:35], v[36:39], v[64:79]
    s_barrier
    ds_read_b64_tr_b16 v[32:33], v48 offset:16384
    ds_read_b64_tr_b16 v[34:35], v48 offset:16896
    ds_read_b128 v[36:39], v50 offset:16384
    v_cvt_pk_bf16_f32 v172, v212, -v216
    v_cvt_pk_bf16_f32 v173, v213, -v217
    v_cvt_pk_bf16_f32 v174, v214, -v218
    v_cvt_pk_bf16_f32 v175, v215, -v219
    v_mul_f32 v220, v212, v228
    s_waitcnt lgkmcnt(9)
    v_mfma_f32_32x32x16_bf16 v[64:79], v[40:43], v[44:47], v[64:79]
    ds_read_b64_tr_b16 v[40:41], v48 offset:18432
    ds_read_b64_tr_b16 v[42:43], v48 offset:18944
    ds_read_b128 v[44:47], v51 offset:16384
    v_mul_f32 v224, v216, v228
    v_fma_f32 v220, -v216, v229, v220
    v_fmac_f32 v224, v212, v229
    v_mul_f32 v221, v213, v228
    v_mul_f32 v225, v217, v228
    s_waitcnt lgkmcnt(9)
    v_mfma_f32_32x32x16_bf16 v[64:79], v[232:235], v[236:239], v[64:79]
    ds_read_b64_tr_b16 v[232:233], v48 offset:20480
    ds_read_b64_tr_b16 v[234:235], v48 offset:20992
    ds_read_b128 v[236:239], v52 offset:16384
    v_fma_f32 v221, -v217, v229, v221
    v_fmac_f32 v225, v213, v229
    v_mul_f32 v222, v214, v228
    v_mul_f32 v226, v218, v228
    v_fma_f32 v222, -v218, v229, v222
    s_waitcnt lgkmcnt(9)
    v_mfma_f32_32x32x16_bf16 v[64:79], v[240:243], v[244:247], v[64:79]
    ds_read_b64_tr_b16 v[240:241], v48 offset:22528
    ds_read_b64_tr_b16 v[242:243], v48 offset:23040
    ds_read_b128 v[244:247], v53 offset:16384
    v_fmac_f32 v226, v214, v229
    v_mul_f32 v223, v215, v228
    v_mul_f32 v227, v219, v228
    v_fma_f32 v223, -v219, v229, v223
    v_fmac_f32 v227, v215, v229
    s_waitcnt lgkmcnt(9)
    v_mfma_f32_32x32x16_bf16 v[64:79], v[32:35], v[36:39], v[64:79]
    s_barrier
    ds_read_b64_tr_b16 v[32:33], v48 offset:32768
    ds_read_b64_tr_b16 v[34:35], v48 offset:33280
    ds_read_b128 v[36:39], v50 offset:32768
    v_cvt_pk_bf16_f32 v176, v220, -v224
    v_cvt_pk_bf16_f32 v177, v221, -v225
    v_cvt_pk_bf16_f32 v178, v222, -v226
    v_cvt_pk_bf16_f32 v179, v223, -v227
    v_mul_f32 v212, v220, v228
    s_waitcnt lgkmcnt(9)
    v_mfma_f32_32x32x16_bf16 v[64:79], v[40:43], v[44:47], v[64:79]
    ds_read_b64_tr_b16 v[40:41], v48 offset:34816
    ds_read_b64_tr_b16 v[42:43], v48 offset:35328
    ds_read_b128 v[44:47], v51 offset:32768
    v_mul_f32 v216, v224, v228
    v_fma_f32 v212, -v224, v229, v212
    v_fmac_f32 v216, v220, v229
    v_mul_f32 v213, v221, v228
    v_mul_f32 v217, v225, v228
    s_waitcnt lgkmcnt(9)
    v_mfma_f32_32x32x16_bf16 v[64:79], v[232:235], v[236:239], v[64:79]
    ds_read_b64_tr_b16 v[232:233], v48 offset:36864
    ds_read_b64_tr_b16 v[234:235], v48 offset:37376
    ds_read_b128 v[236:239], v52 offset:32768
    v_fma_f32 v213, -v225, v229, v213
    v_fmac_f32 v217, v221, v229
    v_mul_f32 v214, v222, v228
    v_mul_f32 v218, v226, v228
    v_fma_f32 v214, -v226, v229, v214
    s_waitcnt lgkmcnt(9)
    v_mfma_f32_32x32x16_bf16 v[64:79], v[240:243], v[244:247], v[64:79]
    ds_read_b64_tr_b16 v[240:241], v48 offset:38912
    ds_read_b64_tr_b16 v[242:243], v48 offset:39424
    ds_read_b128 v[244:247], v53 offset:32768
    v_fmac_f32 v218, v222, v229
    v_mul_f32 v215, v223, v228
    v_mul_f32 v219, v227, v228
    v_fma_f32 v215, -v227, v229, v215
    v_fmac_f32 v219, v223, v229
    s_waitcnt lgkmcnt(9)
    v_mfma_f32_32x32x16_bf16 v[64:79], v[32:35], v[36:39], v[64:79]
    s_barrier
    ds_read_b64_tr_b16 v[32:33], v17 offset:0
    ds_read_b64_tr_b16 v[34:35], v17 offset:512
    ds_read_b128 v[36:39], v20 offset:0
    v_cvt_pk_bf16_f32 v180, v212, -v216
    v_cvt_pk_bf16_f32 v181, v213, -v217
    v_cvt_pk_bf16_f32 v182, v214, -v218
    v_cvt_pk_bf16_f32 v183, v215, -v219
    v_mul_f32 v220, v212, v228
    s_waitcnt lgkmcnt(9)
    v_mfma_f32_32x32x16_bf16 v[64:79], v[40:43], v[44:47], v[64:79]
    ds_read_b64_tr_b16 v[40:41], v17 offset:2048
    ds_read_b64_tr_b16 v[42:43], v17 offset:2560
    ds_read_b128 v[44:47], v21 offset:0
    v_mul_f32 v224, v216, v228
    v_fma_f32 v220, -v216, v229, v220
    v_fmac_f32 v224, v212, v229
    v_mul_f32 v221, v213, v228
    v_mul_f32 v225, v217, v228
    s_waitcnt lgkmcnt(9)
    v_mfma_f32_32x32x16_bf16 v[64:79], v[232:235], v[236:239], v[64:79]
    ds_read_b64_tr_b16 v[232:233], v17 offset:4096
    ds_read_b64_tr_b16 v[234:235], v17 offset:4608
    ds_read_b128 v[236:239], v22 offset:0
    v_fma_f32 v221, -v217, v229, v221
    v_fmac_f32 v225, v213, v229
    v_mul_f32 v222, v214, v228
    v_mul_f32 v226, v218, v228
    v_fma_f32 v222, -v218, v229, v222
    s_waitcnt lgkmcnt(9)
    v_mfma_f32_32x32x16_bf16 v[64:79], v[240:243], v[244:247], v[64:79]
    ds_read_b64_tr_b16 v[240:241], v17 offset:6144
    ds_read_b64_tr_b16 v[242:243], v17 offset:6656
    ds_read_b128 v[244:247], v23 offset:0
    v_fmac_f32 v226, v214, v229
    v_mul_f32 v223, v215, v228
    v_mul_f32 v227, v219, v228
    v_fma_f32 v223, -v219, v229, v223
    v_fmac_f32 v227, v215, v229
    s_waitcnt lgkmcnt(9)
    v_mfma_f32_32x32x16_bf16 v[64:79], v[32:35], v[36:39], v[64:79]
    s_barrier
    ds_read_b64_tr_b16 v[32:33], v17 offset:16384
    ds_read_b64_tr_b16 v[34:35], v17 offset:16896
    ds_read_b128 v[36:39], v20 offset:16384
    v_cvt_pk_bf16_f32 v184, v220, -v224
    v_cvt_pk_bf16_f32 v185, v221, -v225
    v_cvt_pk_bf16_f32 v186, v222, -v226
    v_cvt_pk_bf16_f32 v187, v223, -v227
    v_mul_f32 v212, v220, v228
    s_waitcnt lgkmcnt(9)
    v_mfma_f32_32x32x16_bf16 v[64:79], v[40:43], v[44:47], v[64:79]
    ds_read_b64_tr_b16 v[40:41], v17 offset:18432
    ds_read_b64_tr_b16 v[42:43], v17 offset:18944
    ds_read_b128 v[44:47], v21 offset:16384
    v_mul_f32 v216, v224, v228
    v_fma_f32 v212, -v224, v229, v212
    v_fmac_f32 v216, v220, v229
    v_mul_f32 v213, v221, v228
    v_mul_f32 v217, v225, v228
    s_waitcnt lgkmcnt(9)
    v_mfma_f32_32x32x16_bf16 v[64:79], v[232:235], v[236:239], v[64:79]
    ds_read_b64_tr_b16 v[232:233], v17 offset:20480
    ds_read_b64_tr_b16 v[234:235], v17 offset:20992
    ds_read_b128 v[236:239], v22 offset:16384
    v_fma_f32 v213, -v225, v229, v213
    v_fmac_f32 v217, v221, v229
    v_mul_f32 v214, v222, v228
    v_mul_f32 v218, v226, v228
    v_fma_f32 v214, -v226, v229, v214
    s_waitcnt lgkmcnt(9)
    v_mfma_f32_32x32x16_bf16 v[64:79], v[240:243], v[244:247], v[64:79]
    ds_read_b64_tr_b16 v[240:241], v17 offset:22528
    ds_read_b64_tr_b16 v[242:243], v17 offset:23040
    ds_read_b128 v[244:247], v23 offset:16384
    v_fmac_f32 v218, v222, v229
    v_mul_f32 v215, v223, v228
    v_mul_f32 v219, v227, v228
    v_fma_f32 v215, -v227, v229, v215
    v_fmac_f32 v219, v223, v229
    s_waitcnt lgkmcnt(9)
    v_mfma_f32_32x32x16_bf16 v[64:79], v[32:35], v[36:39], v[64:79]
    s_barrier
    ds_read_b64_tr_b16 v[32:33], v17 offset:32768
    ds_read_b64_tr_b16 v[34:35], v17 offset:33280
    ds_read_b128 v[36:39], v20 offset:32768
    v_cvt_pk_bf16_f32 v188, v212, -v216
    v_cvt_pk_bf16_f32 v189, v213, -v217
    v_cvt_pk_bf16_f32 v190, v214, -v218
    v_cvt_pk_bf16_f32 v191, v215, -v219
    v_mul_f32 v220, v212, v228
    s_waitcnt lgkmcnt(9)
    v_mfma_f32_32x32x16_bf16 v[64:79], v[40:43], v[44:47], v[64:79]
    ds_read_b64_tr_b16 v[40:41], v17 offset:34816
    ds_read_b64_tr_b16 v[42:43], v17 offset:35328
    ds_read_b128 v[44:47], v21 offset:32768
    v_mul_f32 v224, v216, v228
    v_fma_f32 v220, -v216, v229, v220
    v_fmac_f32 v224, v212, v229
    v_mul_f32 v221, v213, v228
    v_mul_f32 v225, v217, v228
    s_waitcnt lgkmcnt(9)
    v_mfma_f32_32x32x16_bf16 v[64:79], v[232:235], v[236:239], v[64:79]
    ds_read_b64_tr_b16 v[232:233], v17 offset:36864
    ds_read_b64_tr_b16 v[234:235], v17 offset:37376
    ds_read_b128 v[236:239], v22 offset:32768
    v_fma_f32 v221, -v217, v229, v221
    v_fmac_f32 v225, v213, v229
    v_mul_f32 v222, v214, v228
    v_mul_f32 v226, v218, v228
    v_fma_f32 v222, -v218, v229, v222
    s_waitcnt lgkmcnt(9)
    v_mfma_f32_32x32x16_bf16 v[64:79], v[240:243], v[244:247], v[64:79]
    ds_read_b64_tr_b16 v[240:241], v17 offset:38912
    ds_read_b64_tr_b16 v[242:243], v17 offset:39424
    ds_read_b128 v[244:247], v23 offset:32768
    v_fmac_f32 v226, v214, v229
    v_mul_f32 v223, v215, v228
    v_mul_f32 v227, v219, v228
    v_fma_f32 v223, -v219, v229, v223
    v_fmac_f32 v227, v215, v229
    s_waitcnt lgkmcnt(9)
    v_mfma_f32_32x32x16_bf16 v[64:79], v[32:35], v[36:39], v[64:79]
    s_barrier
    ds_read_b64_tr_b16 v[32:33], v17 offset:49152
    ds_read_b64_tr_b16 v[34:35], v17 offset:49664
    ds_read_b128 v[36:39], v20 offset:49152
    v_cvt_pk_bf16_f32 v192, v220, -v224
    v_cvt_pk_bf16_f32 v193, v221, -v225
    v_cvt_pk_bf16_f32 v194, v222, -v226
    v_cvt_pk_bf16_f32 v195, v223, -v227
    v_mul_f32 v212, v220, v228
    s_waitcnt lgkmcnt(9)
    v_mfma_f32_32x32x16_bf16 v[64:79], v[40:43], v[44:47], v[64:79]
    ds_read_b64_tr_b16 v[40:41], v17 offset:51200
    ds_read_b64_tr_b16 v[42:43], v17 offset:51712
    ds_read_b128 v[44:47], v21 offset:49152
    v_mul_f32 v216, v224, v228
    v_fma_f32 v212, -v224, v229, v212
    v_fmac_f32 v216, v220, v229
    v_mul_f32 v213, v221, v228
    v_mul_f32 v217, v225, v228
    s_waitcnt lgkmcnt(9)
    v_mfma_f32_32x32x16_bf16 v[64:79], v[232:235], v[236:239], v[64:79]
    ds_read_b64_tr_b16 v[232:233], v17 offset:53248
    ds_read_b64_tr_b16 v[234:235], v17 offset:53760
    ds_read_b128 v[236:239], v22 offset:49152
    v_fma_f32 v213, -v225, v229, v213
    v_fmac_f32 v217, v221, v229
    v_mul_f32 v214, v222, v228
    v_mul_f32 v218, v226, v228
    v_fma_f32 v214, -v226, v229, v214
    s_waitcnt lgkmcnt(9)
    v_mfma_f32_32x32x16_bf16 v[64:79], v[240:243], v[244:247], v[64:79]
    ds_read_b64_tr_b16 v[240:241], v17 offset:55296
    ds_read_b64_tr_b16 v[242:243], v17 offset:55808
    ds_read_b128 v[244:247], v23 offset:49152
    v_fmac_f32 v218, v222, v229
    v_mul_f32 v215, v223, v228
    v_mul_f32 v219, v227, v228
    v_fma_f32 v215, -v227, v229, v215
    v_fmac_f32 v219, v223, v229
    s_waitcnt lgkmcnt(9)
    v_mfma_f32_32x32x16_bf16 v[64:79], v[32:35], v[36:39], v[64:79]
    s_barrier
    ds_read_b64_tr_b16 v[32:33], v48 offset:0
    ds_read_b64_tr_b16 v[34:35], v48 offset:512
    ds_read_b128 v[36:39], v50 offset:0
    v_cvt_pk_bf16_f32 v196, v212, -v216
    v_cvt_pk_bf16_f32 v197, v213, -v217
    v_cvt_pk_bf16_f32 v198, v214, -v218
    v_cvt_pk_bf16_f32 v199, v215, -v219
    v_mul_f32 v220, v212, v228
    s_waitcnt lgkmcnt(9)
    v_mfma_f32_32x32x16_bf16 v[64:79], v[40:43], v[44:47], v[64:79]
    ds_read_b64_tr_b16 v[40:41], v48 offset:2048
    ds_read_b64_tr_b16 v[42:43], v48 offset:2560
    ds_read_b128 v[44:47], v51 offset:0
    v_mul_f32 v224, v216, v228
    v_fma_f32 v220, -v216, v229, v220
    v_fmac_f32 v224, v212, v229
    v_mul_f32 v221, v213, v228
    v_mul_f32 v225, v217, v228
    s_waitcnt lgkmcnt(9)
    v_mfma_f32_32x32x16_bf16 v[64:79], v[232:235], v[236:239], v[64:79]
    ds_read_b64_tr_b16 v[232:233], v48 offset:4096
    ds_read_b64_tr_b16 v[234:235], v48 offset:4608
    ds_read_b128 v[236:239], v52 offset:0
    v_fma_f32 v221, -v217, v229, v221
    v_fmac_f32 v225, v213, v229
    v_mul_f32 v222, v214, v228
    v_mul_f32 v226, v218, v228
    v_fma_f32 v222, -v218, v229, v222
    s_waitcnt lgkmcnt(9)
    v_mfma_f32_32x32x16_bf16 v[64:79], v[240:243], v[244:247], v[64:79]
    ds_read_b64_tr_b16 v[240:241], v48 offset:6144
    ds_read_b64_tr_b16 v[242:243], v48 offset:6656
    ds_read_b128 v[244:247], v53 offset:0
    v_fmac_f32 v226, v214, v229
    v_mul_f32 v223, v215, v228
    v_mul_f32 v227, v219, v228
    v_fma_f32 v223, -v219, v229, v223
    v_fmac_f32 v227, v215, v229
    s_waitcnt lgkmcnt(9)
    v_mfma_f32_32x32x16_bf16 v[64:79], v[32:35], v[36:39], v[64:79]
    s_barrier
    ds_read_b64_tr_b16 v[32:33], v48 offset:16384
    ds_read_b64_tr_b16 v[34:35], v48 offset:16896
    ds_read_b128 v[36:39], v50 offset:16384
    v_cvt_pk_bf16_f32 v200, v220, -v224
    v_cvt_pk_bf16_f32 v201, v221, -v225
    v_cvt_pk_bf16_f32 v202, v222, -v226
    v_cvt_pk_bf16_f32 v203, v223, -v227
    v_mul_f32 v212, v220, v228
    s_waitcnt lgkmcnt(9)
    v_mfma_f32_32x32x16_bf16 v[64:79], v[40:43], v[44:47], v[64:79]
    ds_read_b64_tr_b16 v[40:41], v48 offset:18432
    ds_read_b64_tr_b16 v[42:43], v48 offset:18944
    ds_read_b128 v[44:47], v51 offset:16384
    v_mul_f32 v216, v224, v228
    v_fma_f32 v212, -v224, v229, v212
    v_fmac_f32 v216, v220, v229
    v_mul_f32 v213, v221, v228
    v_mul_f32 v217, v225, v228
    s_waitcnt lgkmcnt(9)
    v_mfma_f32_32x32x16_bf16 v[64:79], v[232:235], v[236:239], v[64:79]
    ds_read_b64_tr_b16 v[232:233], v48 offset:20480
    ds_read_b64_tr_b16 v[234:235], v48 offset:20992
    ds_read_b128 v[236:239], v52 offset:16384
    v_fma_f32 v213, -v225, v229, v213
    v_fmac_f32 v217, v221, v229
    v_mul_f32 v214, v222, v228
    v_mul_f32 v218, v226, v228
    v_fma_f32 v214, -v226, v229, v214
    s_waitcnt lgkmcnt(9)
    v_mfma_f32_32x32x16_bf16 v[64:79], v[240:243], v[244:247], v[64:79]
    ds_read_b64_tr_b16 v[240:241], v48 offset:22528
    ds_read_b64_tr_b16 v[242:243], v48 offset:23040
    ds_read_b128 v[244:247], v53 offset:16384
    v_fmac_f32 v218, v222, v229
    v_mul_f32 v215, v223, v228
    v_mul_f32 v219, v227, v228
    v_fma_f32 v215, -v227, v229, v215
    v_fmac_f32 v219, v223, v229
    s_waitcnt lgkmcnt(9)
    v_mfma_f32_32x32x16_bf16 v[64:79], v[32:35], v[36:39], v[64:79]
    s_barrier
    ds_read_b64_tr_b16 v[32:33], v48 offset:32768
    ds_read_b64_tr_b16 v[34:35], v48 offset:33280
    ds_read_b128 v[36:39], v50 offset:32768
    v_cvt_pk_bf16_f32 v204, v212, -v216
    v_cvt_pk_bf16_f32 v205, v213, -v217
    v_cvt_pk_bf16_f32 v206, v214, -v218
    v_cvt_pk_bf16_f32 v207, v215, -v219
    v_mul_f32 v220, v212, v228
    s_waitcnt lgkmcnt(9)
    v_mfma_f32_32x32x16_bf16 v[64:79], v[40:43], v[44:47], v[64:79]
    ds_read_b64_tr_b16 v[40:41], v48 offset:34816
    ds_read_b64_tr_b16 v[42:43], v48 offset:35328
    ds_read_b128 v[44:47], v51 offset:32768
    v_mul_f32 v224, v216, v228
    v_fma_f32 v220, -v216, v229, v220
    v_fmac_f32 v224, v212, v229
    v_mul_f32 v221, v213, v228
    v_mul_f32 v225, v217, v228
    s_waitcnt lgkmcnt(9)
    v_mfma_f32_32x32x16_bf16 v[64:79], v[232:235], v[236:239], v[64:79]
    ds_read_b64_tr_b16 v[232:233], v48 offset:36864
    ds_read_b64_tr_b16 v[234:235], v48 offset:37376
    ds_read_b128 v[236:239], v52 offset:32768
    v_fma_f32 v221, -v217, v229, v221
    v_fmac_f32 v225, v213, v229
    v_mul_f32 v222, v214, v228
    v_mul_f32 v226, v218, v228
    v_fma_f32 v222, -v218, v229, v222
    s_waitcnt lgkmcnt(9)
    v_mfma_f32_32x32x16_bf16 v[64:79], v[240:243], v[244:247], v[64:79]
    ds_read_b64_tr_b16 v[240:241], v48 offset:38912
    ds_read_b64_tr_b16 v[242:243], v48 offset:39424
    ds_read_b128 v[244:247], v53 offset:32768
    v_fmac_f32 v226, v214, v229
    v_mul_f32 v223, v215, v228
    v_mul_f32 v227, v219, v228
    v_fma_f32 v223, -v219, v229, v223
    v_fmac_f32 v227, v215, v229
    s_waitcnt lgkmcnt(9)
    v_mfma_f32_32x32x16_bf16 v[64:79], v[32:35], v[36:39], v[64:79]
    s_barrier
    ds_read_b64_tr_b16 v[36:37], v18 offset:0
    ds_read_b64_tr_b16 v[38:39], v18 offset:512
    v_cvt_pk_bf16_f32 v208, v220, -v224
    s_waitcnt lgkmcnt(8)
    v_mfma_f32_32x32x16_bf16 v[64:79], v[40:43], v[44:47], v[64:79]
    ds_read_b64_tr_b16 v[44:45], v18 offset:2048
    ds_read_b64_tr_b16 v[46:47], v18 offset:2560
    v_cvt_pk_bf16_f32 v209, v221, -v225
    s_waitcnt lgkmcnt(7)
    v_mfma_f32_32x32x16_bf16 v[64:79], v[232:235], v[236:239], v[64:79]
    ds_read_b64_tr_b16 v[236:237], v18 offset:4096
    ds_read_b64_tr_b16 v[238:239], v18 offset:4608
    v_cvt_pk_bf16_f32 v210, v222, -v226
    s_waitcnt lgkmcnt(6)
    v_mfma_f32_32x32x16_bf16 v[64:79], v[240:243], v[244:247], v[64:79]
    ds_read_b64_tr_b16 v[244:245], v18 offset:6144
    ds_read_b64_tr_b16 v[246:247], v18 offset:6656
    v_cvt_pk_bf16_f32 v211, v223, -v227
    s_waitcnt lgkmcnt(6)
    v_mfma_f32_32x32x16_bf16 v[80:95], v[100:103], v[36:39], v[80:95]
    s_barrier
    ds_read_b64_tr_b16 v[36:37], v18 offset:16384
    ds_read_b64_tr_b16 v[38:39], v18 offset:16896
    s_waitcnt lgkmcnt(6)
    v_mfma_f32_32x32x16_bf16 v[80:95], v[104:107], v[44:47], v[80:95]
    ds_read_b64_tr_b16 v[44:45], v18 offset:18432
    ds_read_b64_tr_b16 v[46:47], v18 offset:18944
    s_waitcnt lgkmcnt(6)
    v_mfma_f32_32x32x16_bf16 v[80:95], v[108:111], v[236:239], v[80:95]
    ds_read_b64_tr_b16 v[236:237], v18 offset:20480
    ds_read_b64_tr_b16 v[238:239], v18 offset:20992
    s_waitcnt lgkmcnt(6)
    v_mfma_f32_32x32x16_bf16 v[80:95], v[112:115], v[244:247], v[80:95]
    ds_read_b64_tr_b16 v[244:245], v18 offset:22528
    ds_read_b64_tr_b16 v[246:247], v18 offset:23040
    s_waitcnt lgkmcnt(6)
    v_mfma_f32_32x32x16_bf16 v[80:95], v[116:119], v[36:39], v[80:95]
    s_barrier
    ds_read_b64_tr_b16 v[36:37], v18 offset:32768
    ds_read_b64_tr_b16 v[38:39], v18 offset:33280
    s_waitcnt lgkmcnt(6)
    v_mfma_f32_32x32x16_bf16 v[80:95], v[120:123], v[44:47], v[80:95]
    ds_read_b64_tr_b16 v[44:45], v18 offset:34816
    ds_read_b64_tr_b16 v[46:47], v18 offset:35328
    s_waitcnt lgkmcnt(6)
    v_mfma_f32_32x32x16_bf16 v[80:95], v[124:127], v[236:239], v[80:95]
    ds_read_b64_tr_b16 v[236:237], v18 offset:36864
    ds_read_b64_tr_b16 v[238:239], v18 offset:37376
    s_waitcnt lgkmcnt(6)
    v_mfma_f32_32x32x16_bf16 v[80:95], v[128:131], v[244:247], v[80:95]
    ds_read_b64_tr_b16 v[244:245], v18 offset:38912
    ds_read_b64_tr_b16 v[246:247], v18 offset:39424
    s_waitcnt lgkmcnt(6)
    v_mfma_f32_32x32x16_bf16 v[80:95], v[132:135], v[36:39], v[80:95]
    s_barrier
    ds_read_b64_tr_b16 v[36:37], v18 offset:49152
    ds_read_b64_tr_b16 v[38:39], v18 offset:49664
    s_waitcnt lgkmcnt(6)
    v_mfma_f32_32x32x16_bf16 v[80:95], v[136:139], v[44:47], v[80:95]
    ds_read_b64_tr_b16 v[44:45], v18 offset:51200
    ds_read_b64_tr_b16 v[46:47], v18 offset:51712
    s_waitcnt lgkmcnt(6)
    v_mfma_f32_32x32x16_bf16 v[80:95], v[140:143], v[236:239], v[80:95]
    ds_read_b64_tr_b16 v[236:237], v18 offset:53248
    ds_read_b64_tr_b16 v[238:239], v18 offset:53760
    s_waitcnt lgkmcnt(6)
    v_mfma_f32_32x32x16_bf16 v[80:95], v[144:147], v[244:247], v[80:95]
    ds_read_b64_tr_b16 v[244:245], v18 offset:55296
    ds_read_b64_tr_b16 v[246:247], v18 offset:55808
    s_waitcnt lgkmcnt(6)
    v_mfma_f32_32x32x16_bf16 v[80:95], v[148:151], v[36:39], v[80:95]
    s_barrier
    ds_read_b64_tr_b16 v[36:37], v49 offset:0
    ds_read_b64_tr_b16 v[38:39], v49 offset:512
    s_waitcnt lgkmcnt(6)
    v_mfma_f32_32x32x16_bf16 v[80:95], v[152:155], v[44:47], v[80:95]
    ds_read_b64_tr_b16 v[44:45], v49 offset:2048
    ds_read_b64_tr_b16 v[46:47], v49 offset:2560
    s_waitcnt lgkmcnt(6)
    v_mfma_f32_32x32x16_bf16 v[80:95], v[156:159], v[236:239], v[80:95]
    ds_read_b64_tr_b16 v[236:237], v49 offset:4096
    ds_read_b64_tr_b16 v[238:239], v49 offset:4608
    s_waitcnt lgkmcnt(6)
    v_mfma_f32_32x32x16_bf16 v[80:95], v[160:163], v[244:247], v[80:95]
    ds_read_b64_tr_b16 v[244:245], v49 offset:6144
    ds_read_b64_tr_b16 v[246:247], v49 offset:6656
    s_waitcnt lgkmcnt(6)
    v_mfma_f32_32x32x16_bf16 v[80:95], v[164:167], v[36:39], v[80:95]
    s_barrier
    ds_read_b64_tr_b16 v[36:37], v49 offset:16384
    ds_read_b64_tr_b16 v[38:39], v49 offset:16896
    s_waitcnt lgkmcnt(6)
    v_mfma_f32_32x32x16_bf16 v[80:95], v[168:171], v[44:47], v[80:95]
    ds_read_b64_tr_b16 v[44:45], v49 offset:18432
    ds_read_b64_tr_b16 v[46:47], v49 offset:18944
    s_waitcnt lgkmcnt(6)
    v_mfma_f32_32x32x16_bf16 v[80:95], v[172:175], v[236:239], v[80:95]
    ds_read_b64_tr_b16 v[236:237], v49 offset:20480
    ds_read_b64_tr_b16 v[238:239], v49 offset:20992
    s_waitcnt lgkmcnt(6)
    v_mfma_f32_32x32x16_bf16 v[80:95], v[176:179], v[244:247], v[80:95]
    ds_read_b64_tr_b16 v[244:245], v49 offset:22528
    ds_read_b64_tr_b16 v[246:247], v49 offset:23040
    s_waitcnt lgkmcnt(6)
    v_mfma_f32_32x32x16_bf16 v[80:95], v[180:183], v[36:39], v[80:95]
    s_barrier
    ds_read_b64_tr_b16 v[36:37], v49 offset:32768
    ds_read_b64_tr_b16 v[38:39], v49 offset:33280
    s_waitcnt lgkmcnt(6)
    v_mfma_f32_32x32x16_bf16 v[80:95], v[184:187], v[44:47], v[80:95]
    ds_read_b64_tr_b16 v[44:45], v49 offset:34816
    ds_read_b64_tr_b16 v[46:47], v49 offset:35328
    s_waitcnt lgkmcnt(6)
    v_mfma_f32_32x32x16_bf16 v[80:95], v[188:191], v[236:239], v[80:95]
    ds_read_b64_tr_b16 v[236:237], v49 offset:36864
    ds_read_b64_tr_b16 v[238:239], v49 offset:37376
    s_waitcnt lgkmcnt(6)
    v_mfma_f32_32x32x16_bf16 v[80:95], v[192:195], v[244:247], v[80:95]
    ds_read_b64_tr_b16 v[244:245], v49 offset:38912
    ds_read_b64_tr_b16 v[246:247], v49 offset:39424
    s_waitcnt lgkmcnt(6)
    v_mfma_f32_32x32x16_bf16 v[80:95], v[196:199], v[36:39], v[80:95]
    s_waitcnt lgkmcnt(4)
    v_mfma_f32_32x32x16_bf16 v[80:95], v[200:203], v[44:47], v[80:95]
    s_waitcnt lgkmcnt(2)
    v_mfma_f32_32x32x16_bf16 v[80:95], v[204:207], v[236:239], v[80:95]
    s_waitcnt lgkmcnt(0)
    v_mfma_f32_32x32x16_bf16 v[80:95], v[208:211], v[244:247], v[80:95]
    s_nop 13
    s_waitcnt vmcnt(0)
    v_cvt_pk_bf16_f32 v32, v80, v81
    v_cvt_pk_bf16_f32 v33, v64, v65
    v_lshlrev_b32 v80, 16, v32
    v_and_b32 v81, 0xffff0000, v32
    v_lshlrev_b32 v64, 16, v33
    v_and_b32 v65, 0xffff0000, v33
    v_lshlrev_b32 v34, 16, v24
    v_and_b32 v35, 0xffff0000, v24
    v_add_f32 v34, v34, v80
    v_add_f32 v35, v35, v81
    v_cvt_pk_bf16_f32 v32, v34, v35
    v_lshlrev_b32 v34, 16, v32
    v_and_b32 v35, 0xffff0000, v32
    v_add_f32 v34, v34, v64
    v_add_f32 v35, v35, v65
    v_cvt_pk_bf16_f32 v40, v34, v35
    v_cvt_pk_bf16_f32 v32, v82, v83
    v_cvt_pk_bf16_f32 v33, v66, v67
    v_lshlrev_b32 v82, 16, v32
    v_and_b32 v83, 0xffff0000, v32
    v_lshlrev_b32 v66, 16, v33
    v_and_b32 v67, 0xffff0000, v33
    v_lshlrev_b32 v34, 16, v25
    v_and_b32 v35, 0xffff0000, v25
    v_add_f32 v34, v34, v82
    v_add_f32 v35, v35, v83
    v_cvt_pk_bf16_f32 v32, v34, v35
    v_lshlrev_b32 v34, 16, v32
    v_and_b32 v35, 0xffff0000, v32
    v_add_f32 v34, v34, v66
    v_add_f32 v35, v35, v67
    v_cvt_pk_bf16_f32 v41, v34, v35
    v_cvt_pk_bf16_f32 v32, v84, v85
    v_cvt_pk_bf16_f32 v33, v68, v69
    v_lshlrev_b32 v84, 16, v32
    v_and_b32 v85, 0xffff0000, v32
    v_lshlrev_b32 v68, 16, v33
    v_and_b32 v69, 0xffff0000, v33
    v_lshlrev_b32 v34, 16, v26
    v_and_b32 v35, 0xffff0000, v26
    v_add_f32 v34, v34, v84
    v_add_f32 v35, v35, v85
    v_cvt_pk_bf16_f32 v32, v34, v35
    v_lshlrev_b32 v34, 16, v32
    v_and_b32 v35, 0xffff0000, v32
    v_add_f32 v34, v34, v68
    v_add_f32 v35, v35, v69
    v_cvt_pk_bf16_f32 v42, v34, v35
    v_cvt_pk_bf16_f32 v32, v86, v87
    v_cvt_pk_bf16_f32 v33, v70, v71
    v_lshlrev_b32 v86, 16, v32
    v_and_b32 v87, 0xffff0000, v32
    v_lshlrev_b32 v70, 16, v33
    v_and_b32 v71, 0xffff0000, v33
    v_lshlrev_b32 v34, 16, v27
    v_and_b32 v35, 0xffff0000, v27
    v_add_f32 v34, v34, v86
    v_add_f32 v35, v35, v87
    v_cvt_pk_bf16_f32 v32, v34, v35
    v_lshlrev_b32 v34, 16, v32
    v_and_b32 v35, 0xffff0000, v32
    v_add_f32 v34, v34, v70
    v_add_f32 v35, v35, v71
    v_cvt_pk_bf16_f32 v43, v34, v35
    v_cvt_pk_bf16_f32 v32, v88, v89
    v_cvt_pk_bf16_f32 v33, v72, v73
    v_lshlrev_b32 v88, 16, v32
    v_and_b32 v89, 0xffff0000, v32
    v_lshlrev_b32 v72, 16, v33
    v_and_b32 v73, 0xffff0000, v33
    v_lshlrev_b32 v34, 16, v28
    v_and_b32 v35, 0xffff0000, v28
    v_add_f32 v34, v34, v88
    v_add_f32 v35, v35, v89
    v_cvt_pk_bf16_f32 v32, v34, v35
    v_lshlrev_b32 v34, 16, v32
    v_and_b32 v35, 0xffff0000, v32
    v_add_f32 v34, v34, v72
    v_add_f32 v35, v35, v73
    v_cvt_pk_bf16_f32 v44, v34, v35
    v_cvt_pk_bf16_f32 v32, v90, v91
    v_cvt_pk_bf16_f32 v33, v74, v75
    v_lshlrev_b32 v90, 16, v32
    v_and_b32 v91, 0xffff0000, v32
    v_lshlrev_b32 v74, 16, v33
    v_and_b32 v75, 0xffff0000, v33
    v_lshlrev_b32 v34, 16, v29
    v_and_b32 v35, 0xffff0000, v29
    v_add_f32 v34, v34, v90
    v_add_f32 v35, v35, v91
    v_cvt_pk_bf16_f32 v32, v34, v35
    v_lshlrev_b32 v34, 16, v32
    v_and_b32 v35, 0xffff0000, v32
    v_add_f32 v34, v34, v74
    v_add_f32 v35, v35, v75
    v_cvt_pk_bf16_f32 v45, v34, v35
    v_cvt_pk_bf16_f32 v32, v92, v93
    v_cvt_pk_bf16_f32 v33, v76, v77
    v_lshlrev_b32 v92, 16, v32
    v_and_b32 v93, 0xffff0000, v32
    v_lshlrev_b32 v76, 16, v33
    v_and_b32 v77, 0xffff0000, v33
    v_lshlrev_b32 v34, 16, v30
    v_and_b32 v35, 0xffff0000, v30
    v_add_f32 v34, v34, v92
    v_add_f32 v35, v35, v93
    v_cvt_pk_bf16_f32 v32, v34, v35
    v_lshlrev_b32 v34, 16, v32
    v_and_b32 v35, 0xffff0000, v32
    v_add_f32 v34, v34, v76
    v_add_f32 v35, v35, v77
    v_cvt_pk_bf16_f32 v46, v34, v35
    v_cvt_pk_bf16_f32 v32, v94, v95
    v_cvt_pk_bf16_f32 v33, v78, v79
    v_lshlrev_b32 v94, 16, v32
    v_and_b32 v95, 0xffff0000, v32
    v_lshlrev_b32 v78, 16, v33
    v_and_b32 v79, 0xffff0000, v33
    v_lshlrev_b32 v34, 16, v31
    v_and_b32 v35, 0xffff0000, v31
    v_add_f32 v34, v34, v94
    v_add_f32 v35, v35, v95
    v_cvt_pk_bf16_f32 v32, v34, v35
    v_lshlrev_b32 v34, 16, v32
    v_and_b32 v35, 0xffff0000, v32
    v_add_f32 v34, v34, v78
    v_add_f32 v35, v35, v79
    v_cvt_pk_bf16_f32 v47, v34, v35
    buffer_store_dwordx4 v[40:43], v14, s[56:59], s9 offen
    buffer_store_dwordx4 v[44:47], v14, s[56:59], s9 offen offset:16
L_k3_end:
    s_endpgm
.section .rodata,"a"
.p2align 6
.amdhsa_kernel k0_kernel
  .amdhsa_next_free_vgpr 212
  .amdhsa_next_free_sgpr 102
  .amdhsa_accum_offset 212
  .amdhsa_group_segment_fixed_size 0
  .amdhsa_kernarg_size 80
  .amdhsa_user_sgpr_count 2
  .amdhsa_user_sgpr_kernarg_segment_ptr 1
  .amdhsa_system_sgpr_workgroup_id_x 1
.end_amdhsa_kernel
.p2align 6
.amdhsa_kernel k1_kernel
  .amdhsa_next_free_vgpr 256
  .amdhsa_next_free_sgpr 102
  .amdhsa_accum_offset 256
  .amdhsa_group_segment_fixed_size 0
  .amdhsa_kernarg_size 80
  .amdhsa_user_sgpr_count 2
  .amdhsa_user_sgpr_kernarg_segment_ptr 1
  .amdhsa_system_sgpr_workgroup_id_x 1
.end_amdhsa_kernel
.p2align 6
.amdhsa_kernel k3_kernel
  .amdhsa_next_free_vgpr 248
  .amdhsa_next_free_sgpr 102
  .amdhsa_accum_offset 248
  .amdhsa_group_segment_fixed_size 0
  .amdhsa_kernarg_size 80
  .amdhsa_user_sgpr_count 2
  .amdhsa_user_sgpr_kernarg_segment_ptr 1
  .amdhsa_system_sgpr_workgroup_id_x 1
.end_amdhsa_kernel
```
